```python
import torch

def _softmax(x, axis=-1):
    return torch.softmax(x, dim=axis)
def _gelu(x):
    return torch.nn.functional.gelu(x, approximate="tanh")
def _silu(x):
    return torch.nn.functional.silu(x)
def _sigmoid(x):
    return torch.sigmoid(x)
def _layernorm(x, axis=-1, eps=1e-5):
    m = x.mean(dim=axis, keepdim=True)
    v = x.var(dim=axis, keepdim=True, unbiased=False)
    return (x - m) / torch.sqrt(v + eps)
def _scatter_add(tgt, idx, src, axis=0):
    return tgt.clone().index_add_(axis, idx, src)
def _segment_sum(src, seg, n):
    out = torch.zeros((n,) + src.shape[1:], dtype=src.dtype)
    return out.index_add_(0, seg, src)
def _pad(x, pw):
    flat = tuple(v for pair in reversed(pw) for v in pair)
    return torch.nn.functional.pad(x, flat)

kernel_name = 'gated_mix__ssm_conv_s5__dense_activation_relu__prompt'

def setup_inputs():

    _w = (lambda a: (lambda t: t.to(torch.bfloat16) if t.is_floating_point() else t)(torch.as_tensor(a)))
    def _A_setup():
        B, S, D = 1, 2048, 640
        P = D
        Lambda_re = -0.5 * (lambda _x: torch.exp(torch.as_tensor(_x)))((lambda *s: torch.randn(*s, dtype=torch.bfloat16) * 0.8)(P))
        Lambda_im = (lambda *s: torch.randn(*s, dtype=torch.bfloat16) * 0.8)(P) * 1.0
        B_re = (lambda *s: torch.randn(*s, dtype=torch.bfloat16) * 0.8)(P, D) * (D ** -0.5)
        B_im = (lambda *s: torch.randn(*s, dtype=torch.bfloat16) * 0.8)(P, D) * (D ** -0.5)
        C_re = (lambda *s: torch.randn(*s, dtype=torch.bfloat16) * 0.8)(D, P) * (P ** -0.5)
        C_im = (lambda *s: torch.randn(*s, dtype=torch.bfloat16) * 0.8)(D, P) * (P ** -0.5)
        log_dt = (lambda *s: torch.randn(*s, dtype=torch.bfloat16) * 0.8)(P) * 0.3 - 2.0
        Dskip = (lambda *s: torch.randn(*s, dtype=torch.bfloat16) * 0.8)(D)
        return {
            "x": _w((lambda *s: torch.randn(*s, dtype=torch.bfloat16) * 0.05)(B, S, D)),
            "Lambda_re": _w(Lambda_re),
            "Lambda_im": _w(Lambda_im),
            "B_re": _w(B_re),
            "B_im": _w(B_im),
            "C_re": _w(C_re),
            "C_im": _w(C_im),
            "log_dt": _w(log_dt),
            "Dskip": _w(Dskip),
        }
    _A_in = _A_setup()

    def _B_setup():
        B, S, D, Dff = 1, 2048, 640, 1728
        return {
            "x": _w((lambda *s: torch.randn(*s, dtype=torch.bfloat16) * 0.05)(B, S, D)),
            "w1": _w((lambda *s: torch.randn(*s, dtype=torch.bfloat16) * 0.05)(D, Dff)),
            "w2": _w((lambda *s: torch.randn(*s, dtype=torch.bfloat16) * 0.05)(Dff, D)),
        }
    _B_in = _B_setup()

    return {
        "A_x": _A_in["x"],
        "A_Lambda_re": _A_in["Lambda_re"],
        "A_Lambda_im": _A_in["Lambda_im"],
        "A_B_re": _A_in["B_re"],
        "A_B_im": _A_in["B_im"],
        "A_C_re": _A_in["C_re"],
        "A_C_im": _A_in["C_im"],
        "A_log_dt": _A_in["log_dt"],
        "A_Dskip": _A_in["Dskip"],
        "B_x": _B_in["x"],
        "B_w1": _B_in["w1"],
        "B_w2": _B_in["w2"],
        "gate_w": _w((lambda *s: torch.randn(*s, dtype=torch.bfloat16) * 0.05)(640) * 16.0),
    }

def reference(A_x, A_Lambda_re, A_Lambda_im, A_B_re, A_B_im, A_C_re, A_C_im, A_log_dt, A_Dskip, B_x, B_w1, B_w2, gate_w):
    def _A_ref(x, Lambda_re, Lambda_im, B_re, B_im, C_re, C_im, log_dt, Dskip):
        Bsz, L, H = x.shape
        Lam = Lambda_re + 1j * Lambda_im
        Bmat = B_re + 1j * B_im
        Cmat = C_re + 1j * C_im
        dt = torch.exp(log_dt)
        Lam_bar = torch.exp(dt * Lam)
        B_bar = ((Lam_bar - 1.0) / Lam)[:, None] * Bmat
        Bu = torch.einsum("bld,pd->blp", x + 0j, B_bar)
        h = torch.zeros_like(Bu[:, 0, :])
        hs = []
        for t in range(L):
            h = Lam_bar[None, :] * h + Bu[:, t, :]
            hs.append(h)
        hseq = torch.stack(hs, 1)
        y = 2.0 * torch.einsum("blp,dp->bld", hseq, Cmat).real + x * Dskip[None, None, :]
        return y

    def _B_ref(x, w1, w2):
        h = torch.einsum("bsd,df->bsf", x, w1)
        zero = torch.zeros_like(h)
        h = torch.maximum(h, zero)
        return torch.einsum("bsf,fd->bsd", h, w2)

    x = A_x
    g = _sigmoid((x * gate_w).sum(-1, keepdims=True))
    a = _A_ref(x, A_Lambda_re, A_Lambda_im, A_B_re, A_B_im, A_C_re, A_C_im, A_log_dt, A_Dskip)
    b = _B_ref(x, B_w1, B_w2)
    return g * a + (1 - g) * b
```

```asm
; @launch kernel=k1_kernel grid=(384,1,1) block=(256,1,1) lds=77824
; @launch kernel=k2_kernel grid=(576,1,1) block=(64,1,1) lds=0
; @launch kernel=k3_kernel grid=(160,1,1) block=(256,1,1) lds=77824
.amdgcn_target "amdgcn-amd-amdhsa--gfx950"
.text
.globl k1_kernel
.p2align 8
.type k1_kernel,@function
k1_kernel:
    s_cmp_ge_u32 s2, 384
    s_cbranch_scc1 K1_END
    s_load_dwordx2 s[4:5], s[0:1], 0
    s_load_dwordx4 s[24:27], s[0:1], 8
    s_load_dwordx4 s[28:31], s[0:1], 24
    s_load_dwordx2 s[32:33], s[0:1], 56
    s_load_dwordx2 s[34:35], s[0:1], 80
    s_load_dwordx2 s[36:37], s[0:1], 120
    v_lshrrev_b32 v1, 3, v0
    v_mul_u32_u24 v1, 144, v1
    v_and_b32 v2, 7, v0
    v_lshl_add_u32 v4, v2, 4, v1
    v_add_u32 v5, 18432, v4
    v_lshrrev_b32 v1, 4, v0
    v_mul_u32_u24 v1, 320, v1
    v_and_b32 v2, 15, v0
    v_lshl_add_u32 v6, v2, 4, v1
    v_add_u32 v6, 18432, v6
    v_and_b32 v1, 31, v0
    v_bfe_u32 v2, v0, 5, 1
    v_lshrrev_b32 v3, 7, v0
    v_mul_u32_u24 v3, 64, v3
    v_add_u32 v3, v3, v1
    v_mul_u32_u24 v3, 144, v3
    v_lshl_add_u32 v7, v2, 4, v3
    v_bfe_u32 v3, v0, 6, 1
    v_mul_u32_u24 v3, 64, v3
    v_add_u32 v3, v3, v1
    v_mul_u32_u24 v3, 144, v3
    v_lshl_add_u32 v3, v2, 4, v3
    v_add_u32 v8, 18432, v3
    v_bfe_u32 v1, v0, 2, 2
    v_lshl_add_u32 v1, v2, 3, v1
    v_mul_u32_u24 v1, 320, v1
    v_bfe_u32 v3, v0, 6, 1
    v_mul_u32_u24 v3, 64, v3
    v_bfe_u32 v2, v0, 4, 1
    v_lshl_add_u32 v3, v2, 4, v3
    v_and_b32 v2, 3, v0
    v_lshl_add_u32 v3, v2, 2, v3
    v_lshl_add_u32 v1, v3, 1, v1
    v_add_u32 v9, 18432, v1
    s_waitcnt lgkmcnt(0)
    s_mov_b32 s8, s4
    s_mov_b32 s9, s5
    s_mov_b32 s10, 2621440
    s_mov_b32 s11, 0x00020000
    s_and_b32 s40, s2, 15
    s_lshl_b32 s41, s40, 7
    v_lshrrev_b32 v1, 3, v0
    v_add_u32 v1, s41, v1
    v_mul_u32_u24 v1, 1280, v1
    v_and_b32 v2, 7, v0
    v_lshl_add_u32 v10, v2, 4, v1
    v_add_u32 v11, 40960, v10
    v_add_u32 v12, 81920, v10
    v_add_u32 v13, 122880, v10
    v_mov_b32 v96, 0
    v_mov_b32 v97, 0
    v_mov_b32 v98, 0
    v_mov_b32 v99, 0
    v_mov_b32 v100, 0
    v_mov_b32 v101, 0
    v_mov_b32 v102, 0
    v_mov_b32 v103, 0
    v_mov_b32 v104, 0
    v_mov_b32 v105, 0
    v_mov_b32 v106, 0
    v_mov_b32 v107, 0
    v_mov_b32 v108, 0
    v_mov_b32 v109, 0
    v_mov_b32 v110, 0
    v_mov_b32 v111, 0
    v_mov_b32 v112, 0
    v_mov_b32 v113, 0
    v_mov_b32 v114, 0
    v_mov_b32 v115, 0
    v_mov_b32 v116, 0
    v_mov_b32 v117, 0
    v_mov_b32 v118, 0
    v_mov_b32 v119, 0
    v_mov_b32 v120, 0
    v_mov_b32 v121, 0
    v_mov_b32 v122, 0
    v_mov_b32 v123, 0
    v_mov_b32 v124, 0
    v_mov_b32 v125, 0
    v_mov_b32 v126, 0
    v_mov_b32 v127, 0
    v_mov_b32 v128, 0
    v_mov_b32 v129, 0
    v_mov_b32 v130, 0
    v_mov_b32 v131, 0
    v_mov_b32 v132, 0
    v_mov_b32 v133, 0
    v_mov_b32 v134, 0
    v_mov_b32 v135, 0
    v_mov_b32 v136, 0
    v_mov_b32 v137, 0
    v_mov_b32 v138, 0
    v_mov_b32 v139, 0
    v_mov_b32 v140, 0
    v_mov_b32 v141, 0
    v_mov_b32 v142, 0
    v_mov_b32 v143, 0
    v_mov_b32 v144, 0
    v_mov_b32 v145, 0
    v_mov_b32 v146, 0
    v_mov_b32 v147, 0
    v_mov_b32 v148, 0
    v_mov_b32 v149, 0
    v_mov_b32 v150, 0
    v_mov_b32 v151, 0
    v_mov_b32 v152, 0
    v_mov_b32 v153, 0
    v_mov_b32 v154, 0
    v_mov_b32 v155, 0
    v_mov_b32 v156, 0
    v_mov_b32 v157, 0
    v_mov_b32 v158, 0
    v_mov_b32 v159, 0
    s_cmp_ge_u32 s2, 160
    s_cbranch_scc1 K1_FFN
    s_lshr_b32 s42, s2, 4
    s_lshl_b32 s43, s42, 6
    s_mov_b32 s12, s28
    s_mov_b32 s13, s29
    s_mov_b32 s14, 819200
    s_mov_b32 s15, 0x00020000
    s_mov_b32 s16, s30
    s_mov_b32 s17, s31
    s_mov_b32 s18, 819200
    s_mov_b32 s19, 0x00020000
    v_lshrrev_b32 v1, 3, v0
    v_add_u32 v1, s43, v1
    v_mul_u32_u24 v1, 1280, v1
    v_and_b32 v2, 7, v0
    v_lshl_add_u32 v14, v2, 4, v1
    v_mov_b32 v15, v14
    v_add_u32 v16, 40960, v14
    v_mov_b32 v17, v16
    s_mov_b32 s90, 0
    s_mov_b32 s91, 0
    buffer_load_dwordx4 v[20:23], v10, s[8:11], s90 offen
    buffer_load_dwordx4 v[24:27], v11, s[8:11], s90 offen
    buffer_load_dwordx4 v[28:31], v12, s[8:11], s90 offen
    buffer_load_dwordx4 v[32:35], v13, s[8:11], s90 offen
    buffer_load_dwordx4 v[36:39], v14, s[12:15], s91 offen
    buffer_load_dwordx4 v[40:43], v15, s[16:19], s91 offen
    buffer_load_dwordx4 v[44:47], v16, s[12:15], s91 offen
    buffer_load_dwordx4 v[48:51], v17, s[16:19], s91 offen
    s_waitcnt vmcnt(0)
    ds_write_b128 v4, v[20:23] offset:0
    ds_write_b128 v4, v[24:27] offset:4608
    ds_write_b128 v4, v[28:31] offset:9216
    ds_write_b128 v4, v[32:35] offset:13824
    ds_write_b128 v5, v[36:39] offset:0
    ds_write_b128 v5, v[40:43] offset:4608
    ds_write_b128 v5, v[44:47] offset:9216
    ds_write_b128 v5, v[48:51] offset:13824
    s_waitcnt lgkmcnt(0)
    s_barrier
    s_mov_b32 s90, 128
    s_mov_b32 s91, 128
    buffer_load_dwordx4 v[20:23], v10, s[8:11], s90 offen
    buffer_load_dwordx4 v[24:27], v11, s[8:11], s90 offen
    buffer_load_dwordx4 v[28:31], v12, s[8:11], s90 offen
    buffer_load_dwordx4 v[32:35], v13, s[8:11], s90 offen
    buffer_load_dwordx4 v[36:39], v14, s[12:15], s91 offen
    buffer_load_dwordx4 v[40:43], v15, s[16:19], s91 offen
    buffer_load_dwordx4 v[44:47], v16, s[12:15], s91 offen
    buffer_load_dwordx4 v[48:51], v17, s[16:19], s91 offen
    ds_read_b128 v[52:55], v7 offset:0
    ds_read_b128 v[56:59], v7 offset:4608
    ds_read_b128 v[68:71], v8 offset:0
    ds_read_b128 v[72:75], v8 offset:4608
    ds_read_b128 v[60:63], v7 offset:32
    ds_read_b128 v[64:67], v7 offset:4640
    ds_read_b128 v[76:79], v8 offset:32
    ds_read_b128 v[80:83], v8 offset:4640
    s_waitcnt lgkmcnt(4)
    v_mfma_f32_32x32x16_bf16 v[96:111], v[52:55], v[68:71], v[96:111]
    v_mfma_f32_32x32x16_bf16 v[112:127], v[52:55], v[72:75], v[112:127]
    v_mfma_f32_32x32x16_bf16 v[128:143], v[56:59], v[68:71], v[128:143]
    v_mfma_f32_32x32x16_bf16 v[144:159], v[56:59], v[72:75], v[144:159]
    ds_read_b128 v[52:55], v7 offset:64
    ds_read_b128 v[56:59], v7 offset:4672
    ds_read_b128 v[68:71], v8 offset:64
    ds_read_b128 v[72:75], v8 offset:4672
    s_waitcnt lgkmcnt(4)
    v_mfma_f32_32x32x16_bf16 v[96:111], v[60:63], v[76:79], v[96:111]
    v_mfma_f32_32x32x16_bf16 v[112:127], v[60:63], v[80:83], v[112:127]
    v_mfma_f32_32x32x16_bf16 v[128:143], v[64:67], v[76:79], v[128:143]
    v_mfma_f32_32x32x16_bf16 v[144:159], v[64:67], v[80:83], v[144:159]
    ds_read_b128 v[60:63], v7 offset:96
    ds_read_b128 v[64:67], v7 offset:4704
    ds_read_b128 v[76:79], v8 offset:96
    ds_read_b128 v[80:83], v8 offset:4704
    s_waitcnt lgkmcnt(4)
    v_mfma_f32_32x32x16_bf16 v[96:111], v[52:55], v[68:71], v[96:111]
    v_mfma_f32_32x32x16_bf16 v[112:127], v[52:55], v[72:75], v[112:127]
    v_mfma_f32_32x32x16_bf16 v[128:143], v[56:59], v[68:71], v[128:143]
    v_mfma_f32_32x32x16_bf16 v[144:159], v[56:59], v[72:75], v[144:159]
    s_waitcnt lgkmcnt(0)
    v_mfma_f32_32x32x16_bf16 v[96:111], v[60:63], v[76:79], v[96:111]
    v_mfma_f32_32x32x16_bf16 v[112:127], v[60:63], v[80:83], v[112:127]
    v_mfma_f32_32x32x16_bf16 v[128:143], v[64:67], v[76:79], v[128:143]
    v_mfma_f32_32x32x16_bf16 v[144:159], v[64:67], v[80:83], v[144:159]
    s_waitcnt vmcnt(0)
    ds_write_b128 v4, v[20:23] offset:38912
    ds_write_b128 v4, v[24:27] offset:43520
    ds_write_b128 v4, v[28:31] offset:48128
    ds_write_b128 v4, v[32:35] offset:52736
    ds_write_b128 v5, v[36:39] offset:38912
    ds_write_b128 v5, v[40:43] offset:43520
    ds_write_b128 v5, v[44:47] offset:48128
    ds_write_b128 v5, v[48:51] offset:52736
    s_waitcnt lgkmcnt(0)
    s_barrier
    s_mov_b32 s90, 256
    s_mov_b32 s91, 256
    buffer_load_dwordx4 v[20:23], v10, s[8:11], s90 offen
    buffer_load_dwordx4 v[24:27], v11, s[8:11], s90 offen
    buffer_load_dwordx4 v[28:31], v12, s[8:11], s90 offen
    buffer_load_dwordx4 v[32:35], v13, s[8:11], s90 offen
    buffer_load_dwordx4 v[36:39], v14, s[12:15], s91 offen
    buffer_load_dwordx4 v[40:43], v15, s[16:19], s91 offen
    buffer_load_dwordx4 v[44:47], v16, s[12:15], s91 offen
    buffer_load_dwordx4 v[48:51], v17, s[16:19], s91 offen
    ds_read_b128 v[52:55], v7 offset:38912
    ds_read_b128 v[56:59], v7 offset:43520
    ds_read_b128 v[68:71], v8 offset:38912
    ds_read_b128 v[72:75], v8 offset:43520
    ds_read_b128 v[60:63], v7 offset:38944
    ds_read_b128 v[64:67], v7 offset:43552
    ds_read_b128 v[76:79], v8 offset:38944
    ds_read_b128 v[80:83], v8 offset:43552
    s_waitcnt lgkmcnt(4)
    v_mfma_f32_32x32x16_bf16 v[96:111], v[52:55], v[68:71], v[96:111]
    v_mfma_f32_32x32x16_bf16 v[112:127], v[52:55], v[72:75], v[112:127]
    v_mfma_f32_32x32x16_bf16 v[128:143], v[56:59], v[68:71], v[128:143]
    v_mfma_f32_32x32x16_bf16 v[144:159], v[56:59], v[72:75], v[144:159]
    ds_read_b128 v[52:55], v7 offset:38976
    ds_read_b128 v[56:59], v7 offset:43584
    ds_read_b128 v[68:71], v8 offset:38976
    ds_read_b128 v[72:75], v8 offset:43584
    s_waitcnt lgkmcnt(4)
    v_mfma_f32_32x32x16_bf16 v[96:111], v[60:63], v[76:79], v[96:111]
    v_mfma_f32_32x32x16_bf16 v[112:127], v[60:63], v[80:83], v[112:127]
    v_mfma_f32_32x32x16_bf16 v[128:143], v[64:67], v[76:79], v[128:143]
    v_mfma_f32_32x32x16_bf16 v[144:159], v[64:67], v[80:83], v[144:159]
    ds_read_b128 v[60:63], v7 offset:39008
    ds_read_b128 v[64:67], v7 offset:43616
    ds_read_b128 v[76:79], v8 offset:39008
    ds_read_b128 v[80:83], v8 offset:43616
    s_waitcnt lgkmcnt(4)
    v_mfma_f32_32x32x16_bf16 v[96:111], v[52:55], v[68:71], v[96:111]
    v_mfma_f32_32x32x16_bf16 v[112:127], v[52:55], v[72:75], v[112:127]
    v_mfma_f32_32x32x16_bf16 v[128:143], v[56:59], v[68:71], v[128:143]
    v_mfma_f32_32x32x16_bf16 v[144:159], v[56:59], v[72:75], v[144:159]
    s_waitcnt lgkmcnt(0)
    v_mfma_f32_32x32x16_bf16 v[96:111], v[60:63], v[76:79], v[96:111]
    v_mfma_f32_32x32x16_bf16 v[112:127], v[60:63], v[80:83], v[112:127]
    v_mfma_f32_32x32x16_bf16 v[128:143], v[64:67], v[76:79], v[128:143]
    v_mfma_f32_32x32x16_bf16 v[144:159], v[64:67], v[80:83], v[144:159]
    s_waitcnt vmcnt(0)
    ds_write_b128 v4, v[20:23] offset:0
    ds_write_b128 v4, v[24:27] offset:4608
    ds_write_b128 v4, v[28:31] offset:9216
    ds_write_b128 v4, v[32:35] offset:13824
    ds_write_b128 v5, v[36:39] offset:0
    ds_write_b128 v5, v[40:43] offset:4608
    ds_write_b128 v5, v[44:47] offset:9216
    ds_write_b128 v5, v[48:51] offset:13824
    s_waitcnt lgkmcnt(0)
    s_barrier
    s_mov_b32 s90, 384
    s_mov_b32 s91, 384
    buffer_load_dwordx4 v[20:23], v10, s[8:11], s90 offen
    buffer_load_dwordx4 v[24:27], v11, s[8:11], s90 offen
    buffer_load_dwordx4 v[28:31], v12, s[8:11], s90 offen
    buffer_load_dwordx4 v[32:35], v13, s[8:11], s90 offen
    buffer_load_dwordx4 v[36:39], v14, s[12:15], s91 offen
    buffer_load_dwordx4 v[40:43], v15, s[16:19], s91 offen
    buffer_load_dwordx4 v[44:47], v16, s[12:15], s91 offen
    buffer_load_dwordx4 v[48:51], v17, s[16:19], s91 offen
    ds_read_b128 v[52:55], v7 offset:0
    ds_read_b128 v[56:59], v7 offset:4608
    ds_read_b128 v[68:71], v8 offset:0
    ds_read_b128 v[72:75], v8 offset:4608
    ds_read_b128 v[60:63], v7 offset:32
    ds_read_b128 v[64:67], v7 offset:4640
    ds_read_b128 v[76:79], v8 offset:32
    ds_read_b128 v[80:83], v8 offset:4640
    s_waitcnt lgkmcnt(4)
    v_mfma_f32_32x32x16_bf16 v[96:111], v[52:55], v[68:71], v[96:111]
    v_mfma_f32_32x32x16_bf16 v[112:127], v[52:55], v[72:75], v[112:127]
    v_mfma_f32_32x32x16_bf16 v[128:143], v[56:59], v[68:71], v[128:143]
    v_mfma_f32_32x32x16_bf16 v[144:159], v[56:59], v[72:75], v[144:159]
    ds_read_b128 v[52:55], v7 offset:64
    ds_read_b128 v[56:59], v7 offset:4672
    ds_read_b128 v[68:71], v8 offset:64
    ds_read_b128 v[72:75], v8 offset:4672
    s_waitcnt lgkmcnt(4)
    v_mfma_f32_32x32x16_bf16 v[96:111], v[60:63], v[76:79], v[96:111]
    v_mfma_f32_32x32x16_bf16 v[112:127], v[60:63], v[80:83], v[112:127]
    v_mfma_f32_32x32x16_bf16 v[128:143], v[64:67], v[76:79], v[128:143]
    v_mfma_f32_32x32x16_bf16 v[144:159], v[64:67], v[80:83], v[144:159]
    ds_read_b128 v[60:63], v7 offset:96
    ds_read_b128 v[64:67], v7 offset:4704
    ds_read_b128 v[76:79], v8 offset:96
    ds_read_b128 v[80:83], v8 offset:4704
    s_waitcnt lgkmcnt(4)
    v_mfma_f32_32x32x16_bf16 v[96:111], v[52:55], v[68:71], v[96:111]
    v_mfma_f32_32x32x16_bf16 v[112:127], v[52:55], v[72:75], v[112:127]
    v_mfma_f32_32x32x16_bf16 v[128:143], v[56:59], v[68:71], v[128:143]
    v_mfma_f32_32x32x16_bf16 v[144:159], v[56:59], v[72:75], v[144:159]
    s_waitcnt lgkmcnt(0)
    v_mfma_f32_32x32x16_bf16 v[96:111], v[60:63], v[76:79], v[96:111]
    v_mfma_f32_32x32x16_bf16 v[112:127], v[60:63], v[80:83], v[112:127]
    v_mfma_f32_32x32x16_bf16 v[128:143], v[64:67], v[76:79], v[128:143]
    v_mfma_f32_32x32x16_bf16 v[144:159], v[64:67], v[80:83], v[144:159]
    s_waitcnt vmcnt(0)
    ds_write_b128 v4, v[20:23] offset:38912
    ds_write_b128 v4, v[24:27] offset:43520
    ds_write_b128 v4, v[28:31] offset:48128
    ds_write_b128 v4, v[32:35] offset:52736
    ds_write_b128 v5, v[36:39] offset:38912
    ds_write_b128 v5, v[40:43] offset:43520
    ds_write_b128 v5, v[44:47] offset:48128
    ds_write_b128 v5, v[48:51] offset:52736
    s_waitcnt lgkmcnt(0)
    s_barrier
    s_mov_b32 s90, 512
    s_mov_b32 s91, 512
    buffer_load_dwordx4 v[20:23], v10, s[8:11], s90 offen
    buffer_load_dwordx4 v[24:27], v11, s[8:11], s90 offen
    buffer_load_dwordx4 v[28:31], v12, s[8:11], s90 offen
    buffer_load_dwordx4 v[32:35], v13, s[8:11], s90 offen
    buffer_load_dwordx4 v[36:39], v14, s[12:15], s91 offen
    buffer_load_dwordx4 v[40:43], v15, s[16:19], s91 offen
    buffer_load_dwordx4 v[44:47], v16, s[12:15], s91 offen
    buffer_load_dwordx4 v[48:51], v17, s[16:19], s91 offen
    ds_read_b128 v[52:55], v7 offset:38912
    ds_read_b128 v[56:59], v7 offset:43520
    ds_read_b128 v[68:71], v8 offset:38912
    ds_read_b128 v[72:75], v8 offset:43520
    ds_read_b128 v[60:63], v7 offset:38944
    ds_read_b128 v[64:67], v7 offset:43552
    ds_read_b128 v[76:79], v8 offset:38944
    ds_read_b128 v[80:83], v8 offset:43552
    s_waitcnt lgkmcnt(4)
    v_mfma_f32_32x32x16_bf16 v[96:111], v[52:55], v[68:71], v[96:111]
    v_mfma_f32_32x32x16_bf16 v[112:127], v[52:55], v[72:75], v[112:127]
    v_mfma_f32_32x32x16_bf16 v[128:143], v[56:59], v[68:71], v[128:143]
    v_mfma_f32_32x32x16_bf16 v[144:159], v[56:59], v[72:75], v[144:159]
    ds_read_b128 v[52:55], v7 offset:38976
    ds_read_b128 v[56:59], v7 offset:43584
    ds_read_b128 v[68:71], v8 offset:38976
    ds_read_b128 v[72:75], v8 offset:43584
    s_waitcnt lgkmcnt(4)
    v_mfma_f32_32x32x16_bf16 v[96:111], v[60:63], v[76:79], v[96:111]
    v_mfma_f32_32x32x16_bf16 v[112:127], v[60:63], v[80:83], v[112:127]
    v_mfma_f32_32x32x16_bf16 v[128:143], v[64:67], v[76:79], v[128:143]
    v_mfma_f32_32x32x16_bf16 v[144:159], v[64:67], v[80:83], v[144:159]
    ds_read_b128 v[60:63], v7 offset:39008
    ds_read_b128 v[64:67], v7 offset:43616
    ds_read_b128 v[76:79], v8 offset:39008
    ds_read_b128 v[80:83], v8 offset:43616
    s_waitcnt lgkmcnt(4)
    v_mfma_f32_32x32x16_bf16 v[96:111], v[52:55], v[68:71], v[96:111]
    v_mfma_f32_32x32x16_bf16 v[112:127], v[52:55], v[72:75], v[112:127]
    v_mfma_f32_32x32x16_bf16 v[128:143], v[56:59], v[68:71], v[128:143]
    v_mfma_f32_32x32x16_bf16 v[144:159], v[56:59], v[72:75], v[144:159]
    s_waitcnt lgkmcnt(0)
    v_mfma_f32_32x32x16_bf16 v[96:111], v[60:63], v[76:79], v[96:111]
    v_mfma_f32_32x32x16_bf16 v[112:127], v[60:63], v[80:83], v[112:127]
    v_mfma_f32_32x32x16_bf16 v[128:143], v[64:67], v[76:79], v[128:143]
    v_mfma_f32_32x32x16_bf16 v[144:159], v[64:67], v[80:83], v[144:159]
    s_waitcnt vmcnt(0)
    ds_write_b128 v4, v[20:23] offset:0
    ds_write_b128 v4, v[24:27] offset:4608
    ds_write_b128 v4, v[28:31] offset:9216
    ds_write_b128 v4, v[32:35] offset:13824
    ds_write_b128 v5, v[36:39] offset:0
    ds_write_b128 v5, v[40:43] offset:4608
    ds_write_b128 v5, v[44:47] offset:9216
    ds_write_b128 v5, v[48:51] offset:13824
    s_waitcnt lgkmcnt(0)
    s_barrier
    s_mov_b32 s90, 640
    s_mov_b32 s91, 640
    buffer_load_dwordx4 v[20:23], v10, s[8:11], s90 offen
    buffer_load_dwordx4 v[24:27], v11, s[8:11], s90 offen
    buffer_load_dwordx4 v[28:31], v12, s[8:11], s90 offen
    buffer_load_dwordx4 v[32:35], v13, s[8:11], s90 offen
    buffer_load_dwordx4 v[36:39], v14, s[12:15], s91 offen
    buffer_load_dwordx4 v[40:43], v15, s[16:19], s91 offen
    buffer_load_dwordx4 v[44:47], v16, s[12:15], s91 offen
    buffer_load_dwordx4 v[48:51], v17, s[16:19], s91 offen
    ds_read_b128 v[52:55], v7 offset:0
    ds_read_b128 v[56:59], v7 offset:4608
    ds_read_b128 v[68:71], v8 offset:0
    ds_read_b128 v[72:75], v8 offset:4608
    ds_read_b128 v[60:63], v7 offset:32
    ds_read_b128 v[64:67], v7 offset:4640
    ds_read_b128 v[76:79], v8 offset:32
    ds_read_b128 v[80:83], v8 offset:4640
    s_waitcnt lgkmcnt(4)
    v_mfma_f32_32x32x16_bf16 v[96:111], v[52:55], v[68:71], v[96:111]
    v_mfma_f32_32x32x16_bf16 v[112:127], v[52:55], v[72:75], v[112:127]
    v_mfma_f32_32x32x16_bf16 v[128:143], v[56:59], v[68:71], v[128:143]
    v_mfma_f32_32x32x16_bf16 v[144:159], v[56:59], v[72:75], v[144:159]
    ds_read_b128 v[52:55], v7 offset:64
    ds_read_b128 v[56:59], v7 offset:4672
    ds_read_b128 v[68:71], v8 offset:64
    ds_read_b128 v[72:75], v8 offset:4672
    s_waitcnt lgkmcnt(4)
    v_mfma_f32_32x32x16_bf16 v[96:111], v[60:63], v[76:79], v[96:111]
    v_mfma_f32_32x32x16_bf16 v[112:127], v[60:63], v[80:83], v[112:127]
    v_mfma_f32_32x32x16_bf16 v[128:143], v[64:67], v[76:79], v[128:143]
    v_mfma_f32_32x32x16_bf16 v[144:159], v[64:67], v[80:83], v[144:159]
    ds_read_b128 v[60:63], v7 offset:96
    ds_read_b128 v[64:67], v7 offset:4704
    ds_read_b128 v[76:79], v8 offset:96
    ds_read_b128 v[80:83], v8 offset:4704
    s_waitcnt lgkmcnt(4)
    v_mfma_f32_32x32x16_bf16 v[96:111], v[52:55], v[68:71], v[96:111]
    v_mfma_f32_32x32x16_bf16 v[112:127], v[52:55], v[72:75], v[112:127]
    v_mfma_f32_32x32x16_bf16 v[128:143], v[56:59], v[68:71], v[128:143]
    v_mfma_f32_32x32x16_bf16 v[144:159], v[56:59], v[72:75], v[144:159]
    s_waitcnt lgkmcnt(0)
    v_mfma_f32_32x32x16_bf16 v[96:111], v[60:63], v[76:79], v[96:111]
    v_mfma_f32_32x32x16_bf16 v[112:127], v[60:63], v[80:83], v[112:127]
    v_mfma_f32_32x32x16_bf16 v[128:143], v[64:67], v[76:79], v[128:143]
    v_mfma_f32_32x32x16_bf16 v[144:159], v[64:67], v[80:83], v[144:159]
    s_waitcnt vmcnt(0)
    ds_write_b128 v4, v[20:23] offset:38912
    ds_write_b128 v4, v[24:27] offset:43520
    ds_write_b128 v4, v[28:31] offset:48128
    ds_write_b128 v4, v[32:35] offset:52736
    ds_write_b128 v5, v[36:39] offset:38912
    ds_write_b128 v5, v[40:43] offset:43520
    ds_write_b128 v5, v[44:47] offset:48128
    ds_write_b128 v5, v[48:51] offset:52736
    s_waitcnt lgkmcnt(0)
    s_barrier
    s_mov_b32 s90, 768
    s_mov_b32 s91, 768
    buffer_load_dwordx4 v[20:23], v10, s[8:11], s90 offen
    buffer_load_dwordx4 v[24:27], v11, s[8:11], s90 offen
    buffer_load_dwordx4 v[28:31], v12, s[8:11], s90 offen
    buffer_load_dwordx4 v[32:35], v13, s[8:11], s90 offen
    buffer_load_dwordx4 v[36:39], v14, s[12:15], s91 offen
    buffer_load_dwordx4 v[40:43], v15, s[16:19], s91 offen
    buffer_load_dwordx4 v[44:47], v16, s[12:15], s91 offen
    buffer_load_dwordx4 v[48:51], v17, s[16:19], s91 offen
    ds_read_b128 v[52:55], v7 offset:38912
    ds_read_b128 v[56:59], v7 offset:43520
    ds_read_b128 v[68:71], v8 offset:38912
    ds_read_b128 v[72:75], v8 offset:43520
    ds_read_b128 v[60:63], v7 offset:38944
    ds_read_b128 v[64:67], v7 offset:43552
    ds_read_b128 v[76:79], v8 offset:38944
    ds_read_b128 v[80:83], v8 offset:43552
    s_waitcnt lgkmcnt(4)
    v_mfma_f32_32x32x16_bf16 v[96:111], v[52:55], v[68:71], v[96:111]
    v_mfma_f32_32x32x16_bf16 v[112:127], v[52:55], v[72:75], v[112:127]
    v_mfma_f32_32x32x16_bf16 v[128:143], v[56:59], v[68:71], v[128:143]
    v_mfma_f32_32x32x16_bf16 v[144:159], v[56:59], v[72:75], v[144:159]
    ds_read_b128 v[52:55], v7 offset:38976
    ds_read_b128 v[56:59], v7 offset:43584
    ds_read_b128 v[68:71], v8 offset:38976
    ds_read_b128 v[72:75], v8 offset:43584
    s_waitcnt lgkmcnt(4)
    v_mfma_f32_32x32x16_bf16 v[96:111], v[60:63], v[76:79], v[96:111]
    v_mfma_f32_32x32x16_bf16 v[112:127], v[60:63], v[80:83], v[112:127]
    v_mfma_f32_32x32x16_bf16 v[128:143], v[64:67], v[76:79], v[128:143]
    v_mfma_f32_32x32x16_bf16 v[144:159], v[64:67], v[80:83], v[144:159]
    ds_read_b128 v[60:63], v7 offset:39008
    ds_read_b128 v[64:67], v7 offset:43616
    ds_read_b128 v[76:79], v8 offset:39008
    ds_read_b128 v[80:83], v8 offset:43616
    s_waitcnt lgkmcnt(4)
    v_mfma_f32_32x32x16_bf16 v[96:111], v[52:55], v[68:71], v[96:111]
    v_mfma_f32_32x32x16_bf16 v[112:127], v[52:55], v[72:75], v[112:127]
    v_mfma_f32_32x32x16_bf16 v[128:143], v[56:59], v[68:71], v[128:143]
    v_mfma_f32_32x32x16_bf16 v[144:159], v[56:59], v[72:75], v[144:159]
    s_waitcnt lgkmcnt(0)
    v_mfma_f32_32x32x16_bf16 v[96:111], v[60:63], v[76:79], v[96:111]
    v_mfma_f32_32x32x16_bf16 v[112:127], v[60:63], v[80:83], v[112:127]
    v_mfma_f32_32x32x16_bf16 v[128:143], v[64:67], v[76:79], v[128:143]
    v_mfma_f32_32x32x16_bf16 v[144:159], v[64:67], v[80:83], v[144:159]
    s_waitcnt vmcnt(0)
    ds_write_b128 v4, v[20:23] offset:0
    ds_write_b128 v4, v[24:27] offset:4608
    ds_write_b128 v4, v[28:31] offset:9216
    ds_write_b128 v4, v[32:35] offset:13824
    ds_write_b128 v5, v[36:39] offset:0
    ds_write_b128 v5, v[40:43] offset:4608
    ds_write_b128 v5, v[44:47] offset:9216
    ds_write_b128 v5, v[48:51] offset:13824
    s_waitcnt lgkmcnt(0)
    s_barrier
    s_mov_b32 s90, 896
    s_mov_b32 s91, 896
    buffer_load_dwordx4 v[20:23], v10, s[8:11], s90 offen
    buffer_load_dwordx4 v[24:27], v11, s[8:11], s90 offen
    buffer_load_dwordx4 v[28:31], v12, s[8:11], s90 offen
    buffer_load_dwordx4 v[32:35], v13, s[8:11], s90 offen
    buffer_load_dwordx4 v[36:39], v14, s[12:15], s91 offen
    buffer_load_dwordx4 v[40:43], v15, s[16:19], s91 offen
    buffer_load_dwordx4 v[44:47], v16, s[12:15], s91 offen
    buffer_load_dwordx4 v[48:51], v17, s[16:19], s91 offen
    ds_read_b128 v[52:55], v7 offset:0
    ds_read_b128 v[56:59], v7 offset:4608
    ds_read_b128 v[68:71], v8 offset:0
    ds_read_b128 v[72:75], v8 offset:4608
    ds_read_b128 v[60:63], v7 offset:32
    ds_read_b128 v[64:67], v7 offset:4640
    ds_read_b128 v[76:79], v8 offset:32
    ds_read_b128 v[80:83], v8 offset:4640
    s_waitcnt lgkmcnt(4)
    v_mfma_f32_32x32x16_bf16 v[96:111], v[52:55], v[68:71], v[96:111]
    v_mfma_f32_32x32x16_bf16 v[112:127], v[52:55], v[72:75], v[112:127]
    v_mfma_f32_32x32x16_bf16 v[128:143], v[56:59], v[68:71], v[128:143]
    v_mfma_f32_32x32x16_bf16 v[144:159], v[56:59], v[72:75], v[144:159]
    ds_read_b128 v[52:55], v7 offset:64
    ds_read_b128 v[56:59], v7 offset:4672
    ds_read_b128 v[68:71], v8 offset:64
    ds_read_b128 v[72:75], v8 offset:4672
    s_waitcnt lgkmcnt(4)
    v_mfma_f32_32x32x16_bf16 v[96:111], v[60:63], v[76:79], v[96:111]
    v_mfma_f32_32x32x16_bf16 v[112:127], v[60:63], v[80:83], v[112:127]
    v_mfma_f32_32x32x16_bf16 v[128:143], v[64:67], v[76:79], v[128:143]
    v_mfma_f32_32x32x16_bf16 v[144:159], v[64:67], v[80:83], v[144:159]
    ds_read_b128 v[60:63], v7 offset:96
    ds_read_b128 v[64:67], v7 offset:4704
    ds_read_b128 v[76:79], v8 offset:96
    ds_read_b128 v[80:83], v8 offset:4704
    s_waitcnt lgkmcnt(4)
    v_mfma_f32_32x32x16_bf16 v[96:111], v[52:55], v[68:71], v[96:111]
    v_mfma_f32_32x32x16_bf16 v[112:127], v[52:55], v[72:75], v[112:127]
    v_mfma_f32_32x32x16_bf16 v[128:143], v[56:59], v[68:71], v[128:143]
    v_mfma_f32_32x32x16_bf16 v[144:159], v[56:59], v[72:75], v[144:159]
    s_waitcnt lgkmcnt(0)
    v_mfma_f32_32x32x16_bf16 v[96:111], v[60:63], v[76:79], v[96:111]
    v_mfma_f32_32x32x16_bf16 v[112:127], v[60:63], v[80:83], v[112:127]
    v_mfma_f32_32x32x16_bf16 v[128:143], v[64:67], v[76:79], v[128:143]
    v_mfma_f32_32x32x16_bf16 v[144:159], v[64:67], v[80:83], v[144:159]
    s_waitcnt vmcnt(0)
    ds_write_b128 v4, v[20:23] offset:38912
    ds_write_b128 v4, v[24:27] offset:43520
    ds_write_b128 v4, v[28:31] offset:48128
    ds_write_b128 v4, v[32:35] offset:52736
    ds_write_b128 v5, v[36:39] offset:38912
    ds_write_b128 v5, v[40:43] offset:43520
    ds_write_b128 v5, v[44:47] offset:48128
    ds_write_b128 v5, v[48:51] offset:52736
    s_waitcnt lgkmcnt(0)
    s_barrier
    s_mov_b32 s90, 1024
    s_mov_b32 s91, 1024
    buffer_load_dwordx4 v[20:23], v10, s[8:11], s90 offen
    buffer_load_dwordx4 v[24:27], v11, s[8:11], s90 offen
    buffer_load_dwordx4 v[28:31], v12, s[8:11], s90 offen
    buffer_load_dwordx4 v[32:35], v13, s[8:11], s90 offen
    buffer_load_dwordx4 v[36:39], v14, s[12:15], s91 offen
    buffer_load_dwordx4 v[40:43], v15, s[16:19], s91 offen
    buffer_load_dwordx4 v[44:47], v16, s[12:15], s91 offen
    buffer_load_dwordx4 v[48:51], v17, s[16:19], s91 offen
    ds_read_b128 v[52:55], v7 offset:38912
    ds_read_b128 v[56:59], v7 offset:43520
    ds_read_b128 v[68:71], v8 offset:38912
    ds_read_b128 v[72:75], v8 offset:43520
    ds_read_b128 v[60:63], v7 offset:38944
    ds_read_b128 v[64:67], v7 offset:43552
    ds_read_b128 v[76:79], v8 offset:38944
    ds_read_b128 v[80:83], v8 offset:43552
    s_waitcnt lgkmcnt(4)
    v_mfma_f32_32x32x16_bf16 v[96:111], v[52:55], v[68:71], v[96:111]
    v_mfma_f32_32x32x16_bf16 v[112:127], v[52:55], v[72:75], v[112:127]
    v_mfma_f32_32x32x16_bf16 v[128:143], v[56:59], v[68:71], v[128:143]
    v_mfma_f32_32x32x16_bf16 v[144:159], v[56:59], v[72:75], v[144:159]
    ds_read_b128 v[52:55], v7 offset:38976
    ds_read_b128 v[56:59], v7 offset:43584
    ds_read_b128 v[68:71], v8 offset:38976
    ds_read_b128 v[72:75], v8 offset:43584
    s_waitcnt lgkmcnt(4)
    v_mfma_f32_32x32x16_bf16 v[96:111], v[60:63], v[76:79], v[96:111]
    v_mfma_f32_32x32x16_bf16 v[112:127], v[60:63], v[80:83], v[112:127]
    v_mfma_f32_32x32x16_bf16 v[128:143], v[64:67], v[76:79], v[128:143]
    v_mfma_f32_32x32x16_bf16 v[144:159], v[64:67], v[80:83], v[144:159]
    ds_read_b128 v[60:63], v7 offset:39008
    ds_read_b128 v[64:67], v7 offset:43616
    ds_read_b128 v[76:79], v8 offset:39008
    ds_read_b128 v[80:83], v8 offset:43616
    s_waitcnt lgkmcnt(4)
    v_mfma_f32_32x32x16_bf16 v[96:111], v[52:55], v[68:71], v[96:111]
    v_mfma_f32_32x32x16_bf16 v[112:127], v[52:55], v[72:75], v[112:127]
    v_mfma_f32_32x32x16_bf16 v[128:143], v[56:59], v[68:71], v[128:143]
    v_mfma_f32_32x32x16_bf16 v[144:159], v[56:59], v[72:75], v[144:159]
    s_waitcnt lgkmcnt(0)
    v_mfma_f32_32x32x16_bf16 v[96:111], v[60:63], v[76:79], v[96:111]
    v_mfma_f32_32x32x16_bf16 v[112:127], v[60:63], v[80:83], v[112:127]
    v_mfma_f32_32x32x16_bf16 v[128:143], v[64:67], v[76:79], v[128:143]
    v_mfma_f32_32x32x16_bf16 v[144:159], v[64:67], v[80:83], v[144:159]
    s_waitcnt vmcnt(0)
    ds_write_b128 v4, v[20:23] offset:0
    ds_write_b128 v4, v[24:27] offset:4608
    ds_write_b128 v4, v[28:31] offset:9216
    ds_write_b128 v4, v[32:35] offset:13824
    ds_write_b128 v5, v[36:39] offset:0
    ds_write_b128 v5, v[40:43] offset:4608
    ds_write_b128 v5, v[44:47] offset:9216
    ds_write_b128 v5, v[48:51] offset:13824
    s_waitcnt lgkmcnt(0)
    s_barrier
    s_mov_b32 s90, 1152
    s_mov_b32 s91, 1152
    buffer_load_dwordx4 v[20:23], v10, s[8:11], s90 offen
    buffer_load_dwordx4 v[24:27], v11, s[8:11], s90 offen
    buffer_load_dwordx4 v[28:31], v12, s[8:11], s90 offen
    buffer_load_dwordx4 v[32:35], v13, s[8:11], s90 offen
    buffer_load_dwordx4 v[36:39], v14, s[12:15], s91 offen
    buffer_load_dwordx4 v[40:43], v15, s[16:19], s91 offen
    buffer_load_dwordx4 v[44:47], v16, s[12:15], s91 offen
    buffer_load_dwordx4 v[48:51], v17, s[16:19], s91 offen
    ds_read_b128 v[52:55], v7 offset:0
    ds_read_b128 v[56:59], v7 offset:4608
    ds_read_b128 v[68:71], v8 offset:0
    ds_read_b128 v[72:75], v8 offset:4608
    ds_read_b128 v[60:63], v7 offset:32
    ds_read_b128 v[64:67], v7 offset:4640
    ds_read_b128 v[76:79], v8 offset:32
    ds_read_b128 v[80:83], v8 offset:4640
    s_waitcnt lgkmcnt(4)
    v_mfma_f32_32x32x16_bf16 v[96:111], v[52:55], v[68:71], v[96:111]
    v_mfma_f32_32x32x16_bf16 v[112:127], v[52:55], v[72:75], v[112:127]
    v_mfma_f32_32x32x16_bf16 v[128:143], v[56:59], v[68:71], v[128:143]
    v_mfma_f32_32x32x16_bf16 v[144:159], v[56:59], v[72:75], v[144:159]
    ds_read_b128 v[52:55], v7 offset:64
    ds_read_b128 v[56:59], v7 offset:4672
    ds_read_b128 v[68:71], v8 offset:64
    ds_read_b128 v[72:75], v8 offset:4672
    s_waitcnt lgkmcnt(4)
    v_mfma_f32_32x32x16_bf16 v[96:111], v[60:63], v[76:79], v[96:111]
    v_mfma_f32_32x32x16_bf16 v[112:127], v[60:63], v[80:83], v[112:127]
    v_mfma_f32_32x32x16_bf16 v[128:143], v[64:67], v[76:79], v[128:143]
    v_mfma_f32_32x32x16_bf16 v[144:159], v[64:67], v[80:83], v[144:159]
    ds_read_b128 v[60:63], v7 offset:96
    ds_read_b128 v[64:67], v7 offset:4704
    ds_read_b128 v[76:79], v8 offset:96
    ds_read_b128 v[80:83], v8 offset:4704
    s_waitcnt lgkmcnt(4)
    v_mfma_f32_32x32x16_bf16 v[96:111], v[52:55], v[68:71], v[96:111]
    v_mfma_f32_32x32x16_bf16 v[112:127], v[52:55], v[72:75], v[112:127]
    v_mfma_f32_32x32x16_bf16 v[128:143], v[56:59], v[68:71], v[128:143]
    v_mfma_f32_32x32x16_bf16 v[144:159], v[56:59], v[72:75], v[144:159]
    s_waitcnt lgkmcnt(0)
    v_mfma_f32_32x32x16_bf16 v[96:111], v[60:63], v[76:79], v[96:111]
    v_mfma_f32_32x32x16_bf16 v[112:127], v[60:63], v[80:83], v[112:127]
    v_mfma_f32_32x32x16_bf16 v[128:143], v[64:67], v[76:79], v[128:143]
    v_mfma_f32_32x32x16_bf16 v[144:159], v[64:67], v[80:83], v[144:159]
    s_waitcnt vmcnt(0)
    ds_write_b128 v4, v[20:23] offset:38912
    ds_write_b128 v4, v[24:27] offset:43520
    ds_write_b128 v4, v[28:31] offset:48128
    ds_write_b128 v4, v[32:35] offset:52736
    ds_write_b128 v5, v[36:39] offset:38912
    ds_write_b128 v5, v[40:43] offset:43520
    ds_write_b128 v5, v[44:47] offset:48128
    ds_write_b128 v5, v[48:51] offset:52736
    s_waitcnt lgkmcnt(0)
    s_barrier
    ds_read_b128 v[52:55], v7 offset:38912
    ds_read_b128 v[56:59], v7 offset:43520
    ds_read_b128 v[68:71], v8 offset:38912
    ds_read_b128 v[72:75], v8 offset:43520
    ds_read_b128 v[60:63], v7 offset:38944
    ds_read_b128 v[64:67], v7 offset:43552
    ds_read_b128 v[76:79], v8 offset:38944
    ds_read_b128 v[80:83], v8 offset:43552
    s_waitcnt lgkmcnt(4)
    v_mfma_f32_32x32x16_bf16 v[96:111], v[52:55], v[68:71], v[96:111]
    v_mfma_f32_32x32x16_bf16 v[112:127], v[52:55], v[72:75], v[112:127]
    v_mfma_f32_32x32x16_bf16 v[128:143], v[56:59], v[68:71], v[128:143]
    v_mfma_f32_32x32x16_bf16 v[144:159], v[56:59], v[72:75], v[144:159]
    ds_read_b128 v[52:55], v7 offset:38976
    ds_read_b128 v[56:59], v7 offset:43584
    ds_read_b128 v[68:71], v8 offset:38976
    ds_read_b128 v[72:75], v8 offset:43584
    s_waitcnt lgkmcnt(4)
    v_mfma_f32_32x32x16_bf16 v[96:111], v[60:63], v[76:79], v[96:111]
    v_mfma_f32_32x32x16_bf16 v[112:127], v[60:63], v[80:83], v[112:127]
    v_mfma_f32_32x32x16_bf16 v[128:143], v[64:67], v[76:79], v[128:143]
    v_mfma_f32_32x32x16_bf16 v[144:159], v[64:67], v[80:83], v[144:159]
    ds_read_b128 v[60:63], v7 offset:39008
    ds_read_b128 v[64:67], v7 offset:43616
    ds_read_b128 v[76:79], v8 offset:39008
    ds_read_b128 v[80:83], v8 offset:43616
    s_waitcnt lgkmcnt(4)
    v_mfma_f32_32x32x16_bf16 v[96:111], v[52:55], v[68:71], v[96:111]
    v_mfma_f32_32x32x16_bf16 v[112:127], v[52:55], v[72:75], v[112:127]
    v_mfma_f32_32x32x16_bf16 v[128:143], v[56:59], v[68:71], v[128:143]
    v_mfma_f32_32x32x16_bf16 v[144:159], v[56:59], v[72:75], v[144:159]
    s_waitcnt lgkmcnt(0)
    v_mfma_f32_32x32x16_bf16 v[96:111], v[60:63], v[76:79], v[96:111]
    v_mfma_f32_32x32x16_bf16 v[112:127], v[60:63], v[80:83], v[112:127]
    v_mfma_f32_32x32x16_bf16 v[128:143], v[64:67], v[76:79], v[128:143]
    v_mfma_f32_32x32x16_bf16 v[144:159], v[64:67], v[80:83], v[144:159]
    s_barrier
    s_mov_b32 s44, s24
    s_mov_b32 s45, s25
    s_mov_b32 s46, 1280
    s_mov_b32 s47, 0x00020000
    s_mov_b32 s48, s26
    s_mov_b32 s49, s27
    s_mov_b32 s50, 1280
    s_mov_b32 s51, 0x00020000
    s_mov_b32 s52, s32
    s_mov_b32 s53, s33
    s_mov_b32 s54, 1280
    s_mov_b32 s55, 0x00020000
    v_and_b32 v1, 31, v0
    v_bfe_u32 v2, v0, 6, 1
    v_lshl_add_u32 v1, v2, 5, v1
    v_add_u32 v2, s43, v1
    v_lshlrev_b32 v2, 1, v2
    buffer_load_ushort v24, v2, s[44:47], 0 offen
    buffer_load_ushort v25, v2, s[48:51], 0 offen
    buffer_load_ushort v26, v2, s[52:55], 0 offen
    s_waitcnt vmcnt(0)
    v_lshlrev_b32 v24, 16, v24
    v_lshlrev_b32 v25, 16, v25
    v_lshlrev_b32 v26, 16, v26
    v_mul_f32 v26, 0x3fb8aa3b, v26
    v_exp_f32 v26, v26
    s_nop 0
    v_cvt_pk_bf16_f32 v26, v26, v26
    v_lshlrev_b32 v26, 16, v26
    v_mul_f32 v27, v26, v24
    v_mul_f32 v28, v26, v25
    v_mul_f32 v27, 0x3fb8aa3b, v27
    v_exp_f32 v27, v27
    v_mul_f32 v28, 0.15915494, v28
    v_cos_f32 v29, v28
    v_sin_f32 v28, v28
    s_nop 0
    v_mul_f32 v20, v27, v29
    v_mul_f32 v21, v27, v28
    v_add_f32 v27, -1.0, v20
    v_mul_f32 v28, v24, v24
    v_fmac_f32 v28, v25, v25
    v_rcp_f32 v28, v28
    v_mul_f32 v29, v27, v24
    v_fmac_f32 v29, v21, v25
    v_mul_f32 v23, v21, v24
    v_fma_f32 v23, -v27, v25, v23
    v_mul_f32 v22, v29, v28
    v_mul_f32 v23, v23, v28
    v_mul_u32_u24 v3, 528, v1
    v_lshrrev_b32 v2, 7, v0
    v_lshlrev_b32 v2, 8, v2
    v_add_u32 v3, v3, v2
    v_bfe_u32 v2, v0, 5, 1
    v_lshl_add_u32 v3, v2, 4, v3
    s_nop 7
    s_nop 7
    v_mul_f32 v28, v22, v96
    v_fma_f32 v28, -v23, v112, v28
    v_mul_f32 v32, v22, v112
    v_fma_f32 v32, v23, v96, v32
    v_mul_f32 v29, v22, v97
    v_fma_f32 v29, -v23, v113, v29
    v_mul_f32 v33, v22, v113
    v_fma_f32 v33, v23, v97, v33
    v_mul_f32 v30, v22, v98
    v_fma_f32 v30, -v23, v114, v30
    v_mul_f32 v34, v22, v114
    v_fma_f32 v34, v23, v98, v34
    v_mul_f32 v31, v22, v99
    v_fma_f32 v31, -v23, v115, v31
    v_mul_f32 v35, v22, v115
    v_fma_f32 v35, v23, v99, v35
    ds_write_b128 v3, v[28:31] offset:0
    ds_write_b128 v3, v[32:35] offset:33792
    s_nop 1
    v_mul_f32 v28, v22, v100
    v_fma_f32 v28, -v23, v116, v28
    v_mul_f32 v32, v22, v116
    v_fma_f32 v32, v23, v100, v32
    v_mul_f32 v29, v22, v101
    v_fma_f32 v29, -v23, v117, v29
    v_mul_f32 v33, v22, v117
    v_fma_f32 v33, v23, v101, v33
    v_mul_f32 v30, v22, v102
    v_fma_f32 v30, -v23, v118, v30
    v_mul_f32 v34, v22, v118
    v_fma_f32 v34, v23, v102, v34
    v_mul_f32 v31, v22, v103
    v_fma_f32 v31, -v23, v119, v31
    v_mul_f32 v35, v22, v119
    v_fma_f32 v35, v23, v103, v35
    ds_write_b128 v3, v[28:31] offset:32
    ds_write_b128 v3, v[32:35] offset:33824
    s_nop 1
    v_mul_f32 v28, v22, v104
    v_fma_f32 v28, -v23, v120, v28
    v_mul_f32 v32, v22, v120
    v_fma_f32 v32, v23, v104, v32
    v_mul_f32 v29, v22, v105
    v_fma_f32 v29, -v23, v121, v29
    v_mul_f32 v33, v22, v121
    v_fma_f32 v33, v23, v105, v33
    v_mul_f32 v30, v22, v106
    v_fma_f32 v30, -v23, v122, v30
    v_mul_f32 v34, v22, v122
    v_fma_f32 v34, v23, v106, v34
    v_mul_f32 v31, v22, v107
    v_fma_f32 v31, -v23, v123, v31
    v_mul_f32 v35, v22, v123
    v_fma_f32 v35, v23, v107, v35
    ds_write_b128 v3, v[28:31] offset:64
    ds_write_b128 v3, v[32:35] offset:33856
    s_nop 1
    v_mul_f32 v28, v22, v108
    v_fma_f32 v28, -v23, v124, v28
    v_mul_f32 v32, v22, v124
    v_fma_f32 v32, v23, v108, v32
    v_mul_f32 v29, v22, v109
    v_fma_f32 v29, -v23, v125, v29
    v_mul_f32 v33, v22, v125
    v_fma_f32 v33, v23, v109, v33
    v_mul_f32 v30, v22, v110
    v_fma_f32 v30, -v23, v126, v30
    v_mul_f32 v34, v22, v126
    v_fma_f32 v34, v23, v110, v34
    v_mul_f32 v31, v22, v111
    v_fma_f32 v31, -v23, v127, v31
    v_mul_f32 v35, v22, v127
    v_fma_f32 v35, v23, v111, v35
    ds_write_b128 v3, v[28:31] offset:96
    ds_write_b128 v3, v[32:35] offset:33888
    s_nop 1
    v_mul_f32 v28, v22, v128
    v_fma_f32 v28, -v23, v144, v28
    v_mul_f32 v32, v22, v144
    v_fma_f32 v32, v23, v128, v32
    v_mul_f32 v29, v22, v129
    v_fma_f32 v29, -v23, v145, v29
    v_mul_f32 v33, v22, v145
    v_fma_f32 v33, v23, v129, v33
    v_mul_f32 v30, v22, v130
    v_fma_f32 v30, -v23, v146, v30
    v_mul_f32 v34, v22, v146
    v_fma_f32 v34, v23, v130, v34
    v_mul_f32 v31, v22, v131
    v_fma_f32 v31, -v23, v147, v31
    v_mul_f32 v35, v22, v147
    v_fma_f32 v35, v23, v131, v35
    ds_write_b128 v3, v[28:31] offset:128
    ds_write_b128 v3, v[32:35] offset:33920
    s_nop 1
    v_mul_f32 v28, v22, v132
    v_fma_f32 v28, -v23, v148, v28
    v_mul_f32 v32, v22, v148
    v_fma_f32 v32, v23, v132, v32
    v_mul_f32 v29, v22, v133
    v_fma_f32 v29, -v23, v149, v29
    v_mul_f32 v33, v22, v149
    v_fma_f32 v33, v23, v133, v33
    v_mul_f32 v30, v22, v134
    v_fma_f32 v30, -v23, v150, v30
    v_mul_f32 v34, v22, v150
    v_fma_f32 v34, v23, v134, v34
    v_mul_f32 v31, v22, v135
    v_fma_f32 v31, -v23, v151, v31
    v_mul_f32 v35, v22, v151
    v_fma_f32 v35, v23, v135, v35
    ds_write_b128 v3, v[28:31] offset:160
    ds_write_b128 v3, v[32:35] offset:33952
    s_nop 1
    v_mul_f32 v28, v22, v136
    v_fma_f32 v28, -v23, v152, v28
    v_mul_f32 v32, v22, v152
    v_fma_f32 v32, v23, v136, v32
    v_mul_f32 v29, v22, v137
    v_fma_f32 v29, -v23, v153, v29
    v_mul_f32 v33, v22, v153
    v_fma_f32 v33, v23, v137, v33
    v_mul_f32 v30, v22, v138
    v_fma_f32 v30, -v23, v154, v30
    v_mul_f32 v34, v22, v154
    v_fma_f32 v34, v23, v138, v34
    v_mul_f32 v31, v22, v139
    v_fma_f32 v31, -v23, v155, v31
    v_mul_f32 v35, v22, v155
    v_fma_f32 v35, v23, v139, v35
    ds_write_b128 v3, v[28:31] offset:192
    ds_write_b128 v3, v[32:35] offset:33984
    s_nop 1
    v_mul_f32 v28, v22, v140
    v_fma_f32 v28, -v23, v156, v28
    v_mul_f32 v32, v22, v156
    v_fma_f32 v32, v23, v140, v32
    v_mul_f32 v29, v22, v141
    v_fma_f32 v29, -v23, v157, v29
    v_mul_f32 v33, v22, v157
    v_fma_f32 v33, v23, v141, v33
    v_mul_f32 v30, v22, v142
    v_fma_f32 v30, -v23, v158, v30
    v_mul_f32 v34, v22, v158
    v_fma_f32 v34, v23, v142, v34
    v_mul_f32 v31, v22, v143
    v_fma_f32 v31, -v23, v159, v31
    v_mul_f32 v35, v22, v159
    v_fma_f32 v35, v23, v143, v35
    ds_write_b128 v3, v[28:31] offset:224
    ds_write_b128 v3, v[32:35] offset:34016
    s_nop 1
    s_waitcnt lgkmcnt(0)
    s_barrier
    v_and_b32 v1, 63, v0
    v_add_u32 v2, s43, v1
    v_lshlrev_b32 v2, 1, v2
    buffer_load_ushort v24, v2, s[44:47], 0 offen
    buffer_load_ushort v25, v2, s[48:51], 0 offen
    buffer_load_ushort v26, v2, s[52:55], 0 offen
    s_waitcnt vmcnt(0)
    v_lshlrev_b32 v24, 16, v24
    v_lshlrev_b32 v25, 16, v25
    v_lshlrev_b32 v26, 16, v26
    v_mul_f32 v26, 0x3fb8aa3b, v26
    v_exp_f32 v26, v26
    s_nop 0
    v_cvt_pk_bf16_f32 v26, v26, v26
    v_lshlrev_b32 v26, 16, v26
    v_mul_f32 v27, v26, v24
    v_mul_f32 v28, v26, v25
    v_mul_f32 v27, 0x3fb8aa3b, v27
    v_exp_f32 v27, v27
    v_mul_f32 v28, 0.15915494, v28
    v_cos_f32 v29, v28
    v_sin_f32 v28, v28
    s_nop 0
    v_mul_f32 v20, v27, v29
    v_mul_f32 v21, v27, v28
    v_add_f32 v27, -1.0, v20
    v_mul_f32 v28, v24, v24
    v_fmac_f32 v28, v25, v25
    v_rcp_f32 v28, v28
    v_mul_f32 v29, v27, v24
    v_fmac_f32 v29, v21, v25
    v_mul_f32 v23, v21, v24
    v_fma_f32 v23, -v27, v25, v23
    v_mul_f32 v22, v29, v28
    v_mul_f32 v23, v23, v28
    v_mul_u32_u24 v3, 528, v1
    v_lshrrev_b32 v2, 6, v0
    v_lshl_add_u32 v3, v2, 7, v3
    ds_read_b128 v[32:35], v3 offset:0
    ds_read_b128 v[64:67], v3 offset:33792
    ds_read_b128 v[36:39], v3 offset:16
    ds_read_b128 v[68:71], v3 offset:33808
    ds_read_b128 v[40:43], v3 offset:32
    ds_read_b128 v[72:75], v3 offset:33824
    ds_read_b128 v[44:47], v3 offset:48
    ds_read_b128 v[76:79], v3 offset:33840
    ds_read_b128 v[48:51], v3 offset:64
    ds_read_b128 v[80:83], v3 offset:33856
    ds_read_b128 v[52:55], v3 offset:80
    ds_read_b128 v[84:87], v3 offset:33872
    ds_read_b128 v[56:59], v3 offset:96
    ds_read_b128 v[88:91], v3 offset:33888
    ds_read_b128 v[60:63], v3 offset:112
    ds_read_b128 v[92:95], v3 offset:33904
    s_add_u32 s56, s36, 8388608
    s_addc_u32 s57, s37, 0
    s_mov_b32 s58, 10485760
    s_mov_b32 s59, 0x00020000
    s_add_u32 s60, s36, 20971520
    s_addc_u32 s61, s37, 0
    s_mov_b32 s62, 327680
    s_mov_b32 s63, 0x00020000
    v_readfirstlane_b32 s64, v2
    s_lshl_b32 s65, s40, 2
    s_add_u32 s65, s65, s64
    s_lshl_b32 s66, s65, 5
    s_mul_i32 s67, s66, 5120
    v_add_u32 v4, s43, v1
    v_lshlrev_b32 v4, 2, v4
    v_add_u32 v5, 2560, v4
    v_mov_b32 v6, 0
    v_mov_b32 v7, 0
    s_waitcnt lgkmcnt(0)
    v_fma_f32 v8, v20, v6, v32
    v_fma_f32 v9, v20, v7, v64
    v_fma_f32 v8, -v21, v7, v8
    v_fma_f32 v7, v21, v6, v9
    v_mov_b32 v6, v8
    buffer_store_dword v6, v4, s[56:59], s67 offen
    buffer_store_dword v7, v5, s[56:59], s67 offen
    s_add_u32 s67, s67, 5120
    v_fma_f32 v8, v20, v6, v33
    v_fma_f32 v9, v20, v7, v65
    v_fma_f32 v8, -v21, v7, v8
    v_fma_f32 v7, v21, v6, v9
    v_mov_b32 v6, v8
    buffer_store_dword v6, v4, s[56:59], s67 offen
    buffer_store_dword v7, v5, s[56:59], s67 offen
    s_add_u32 s67, s67, 5120
    v_fma_f32 v8, v20, v6, v34
    v_fma_f32 v9, v20, v7, v66
    v_fma_f32 v8, -v21, v7, v8
    v_fma_f32 v7, v21, v6, v9
    v_mov_b32 v6, v8
    buffer_store_dword v6, v4, s[56:59], s67 offen
    buffer_store_dword v7, v5, s[56:59], s67 offen
    s_add_u32 s67, s67, 5120
    v_fma_f32 v8, v20, v6, v35
    v_fma_f32 v9, v20, v7, v67
    v_fma_f32 v8, -v21, v7, v8
    v_fma_f32 v7, v21, v6, v9
    v_mov_b32 v6, v8
    buffer_store_dword v6, v4, s[56:59], s67 offen
    buffer_store_dword v7, v5, s[56:59], s67 offen
    s_add_u32 s67, s67, 5120
    v_fma_f32 v8, v20, v6, v36
    v_fma_f32 v9, v20, v7, v68
    v_fma_f32 v8, -v21, v7, v8
    v_fma_f32 v7, v21, v6, v9
    v_mov_b32 v6, v8
    buffer_store_dword v6, v4, s[56:59], s67 offen
    buffer_store_dword v7, v5, s[56:59], s67 offen
    s_add_u32 s67, s67, 5120
    v_fma_f32 v8, v20, v6, v37
    v_fma_f32 v9, v20, v7, v69
    v_fma_f32 v8, -v21, v7, v8
    v_fma_f32 v7, v21, v6, v9
    v_mov_b32 v6, v8
    buffer_store_dword v6, v4, s[56:59], s67 offen
    buffer_store_dword v7, v5, s[56:59], s67 offen
    s_add_u32 s67, s67, 5120
    v_fma_f32 v8, v20, v6, v38
    v_fma_f32 v9, v20, v7, v70
    v_fma_f32 v8, -v21, v7, v8
    v_fma_f32 v7, v21, v6, v9
    v_mov_b32 v6, v8
    buffer_store_dword v6, v4, s[56:59], s67 offen
    buffer_store_dword v7, v5, s[56:59], s67 offen
    s_add_u32 s67, s67, 5120
    v_fma_f32 v8, v20, v6, v39
    v_fma_f32 v9, v20, v7, v71
    v_fma_f32 v8, -v21, v7, v8
    v_fma_f32 v7, v21, v6, v9
    v_mov_b32 v6, v8
    buffer_store_dword v6, v4, s[56:59], s67 offen
    buffer_store_dword v7, v5, s[56:59], s67 offen
    s_add_u32 s67, s67, 5120
    v_fma_f32 v8, v20, v6, v40
    v_fma_f32 v9, v20, v7, v72
    v_fma_f32 v8, -v21, v7, v8
    v_fma_f32 v7, v21, v6, v9
    v_mov_b32 v6, v8
    buffer_store_dword v6, v4, s[56:59], s67 offen
    buffer_store_dword v7, v5, s[56:59], s67 offen
    s_add_u32 s67, s67, 5120
    v_fma_f32 v8, v20, v6, v41
    v_fma_f32 v9, v20, v7, v73
    v_fma_f32 v8, -v21, v7, v8
    v_fma_f32 v7, v21, v6, v9
    v_mov_b32 v6, v8
    buffer_store_dword v6, v4, s[56:59], s67 offen
    buffer_store_dword v7, v5, s[56:59], s67 offen
    s_add_u32 s67, s67, 5120
    v_fma_f32 v8, v20, v6, v42
    v_fma_f32 v9, v20, v7, v74
    v_fma_f32 v8, -v21, v7, v8
    v_fma_f32 v7, v21, v6, v9
    v_mov_b32 v6, v8
    buffer_store_dword v6, v4, s[56:59], s67 offen
    buffer_store_dword v7, v5, s[56:59], s67 offen
    s_add_u32 s67, s67, 5120
    v_fma_f32 v8, v20, v6, v43
    v_fma_f32 v9, v20, v7, v75
    v_fma_f32 v8, -v21, v7, v8
    v_fma_f32 v7, v21, v6, v9
    v_mov_b32 v6, v8
    buffer_store_dword v6, v4, s[56:59], s67 offen
    buffer_store_dword v7, v5, s[56:59], s67 offen
    s_add_u32 s67, s67, 5120
    v_fma_f32 v8, v20, v6, v44
    v_fma_f32 v9, v20, v7, v76
    v_fma_f32 v8, -v21, v7, v8
    v_fma_f32 v7, v21, v6, v9
    v_mov_b32 v6, v8
    buffer_store_dword v6, v4, s[56:59], s67 offen
    buffer_store_dword v7, v5, s[56:59], s67 offen
    s_add_u32 s67, s67, 5120
    v_fma_f32 v8, v20, v6, v45
    v_fma_f32 v9, v20, v7, v77
    v_fma_f32 v8, -v21, v7, v8
    v_fma_f32 v7, v21, v6, v9
    v_mov_b32 v6, v8
    buffer_store_dword v6, v4, s[56:59], s67 offen
    buffer_store_dword v7, v5, s[56:59], s67 offen
    s_add_u32 s67, s67, 5120
    v_fma_f32 v8, v20, v6, v46
    v_fma_f32 v9, v20, v7, v78
    v_fma_f32 v8, -v21, v7, v8
    v_fma_f32 v7, v21, v6, v9
    v_mov_b32 v6, v8
    buffer_store_dword v6, v4, s[56:59], s67 offen
    buffer_store_dword v7, v5, s[56:59], s67 offen
    s_add_u32 s67, s67, 5120
    v_fma_f32 v8, v20, v6, v47
    v_fma_f32 v9, v20, v7, v79
    v_fma_f32 v8, -v21, v7, v8
    v_fma_f32 v7, v21, v6, v9
    v_mov_b32 v6, v8
    buffer_store_dword v6, v4, s[56:59], s67 offen
    buffer_store_dword v7, v5, s[56:59], s67 offen
    s_add_u32 s67, s67, 5120
    v_fma_f32 v8, v20, v6, v48
    v_fma_f32 v9, v20, v7, v80
    v_fma_f32 v8, -v21, v7, v8
    v_fma_f32 v7, v21, v6, v9
    v_mov_b32 v6, v8
    buffer_store_dword v6, v4, s[56:59], s67 offen
    buffer_store_dword v7, v5, s[56:59], s67 offen
    s_add_u32 s67, s67, 5120
    v_fma_f32 v8, v20, v6, v49
    v_fma_f32 v9, v20, v7, v81
    v_fma_f32 v8, -v21, v7, v8
    v_fma_f32 v7, v21, v6, v9
    v_mov_b32 v6, v8
    buffer_store_dword v6, v4, s[56:59], s67 offen
    buffer_store_dword v7, v5, s[56:59], s67 offen
    s_add_u32 s67, s67, 5120
    v_fma_f32 v8, v20, v6, v50
    v_fma_f32 v9, v20, v7, v82
    v_fma_f32 v8, -v21, v7, v8
    v_fma_f32 v7, v21, v6, v9
    v_mov_b32 v6, v8
    buffer_store_dword v6, v4, s[56:59], s67 offen
    buffer_store_dword v7, v5, s[56:59], s67 offen
    s_add_u32 s67, s67, 5120
    v_fma_f32 v8, v20, v6, v51
    v_fma_f32 v9, v20, v7, v83
    v_fma_f32 v8, -v21, v7, v8
    v_fma_f32 v7, v21, v6, v9
    v_mov_b32 v6, v8
    buffer_store_dword v6, v4, s[56:59], s67 offen
    buffer_store_dword v7, v5, s[56:59], s67 offen
    s_add_u32 s67, s67, 5120
    v_fma_f32 v8, v20, v6, v52
    v_fma_f32 v9, v20, v7, v84
    v_fma_f32 v8, -v21, v7, v8
    v_fma_f32 v7, v21, v6, v9
    v_mov_b32 v6, v8
    buffer_store_dword v6, v4, s[56:59], s67 offen
    buffer_store_dword v7, v5, s[56:59], s67 offen
    s_add_u32 s67, s67, 5120
    v_fma_f32 v8, v20, v6, v53
    v_fma_f32 v9, v20, v7, v85
    v_fma_f32 v8, -v21, v7, v8
    v_fma_f32 v7, v21, v6, v9
    v_mov_b32 v6, v8
    buffer_store_dword v6, v4, s[56:59], s67 offen
    buffer_store_dword v7, v5, s[56:59], s67 offen
    s_add_u32 s67, s67, 5120
    v_fma_f32 v8, v20, v6, v54
    v_fma_f32 v9, v20, v7, v86
    v_fma_f32 v8, -v21, v7, v8
    v_fma_f32 v7, v21, v6, v9
    v_mov_b32 v6, v8
    buffer_store_dword v6, v4, s[56:59], s67 offen
    buffer_store_dword v7, v5, s[56:59], s67 offen
    s_add_u32 s67, s67, 5120
    v_fma_f32 v8, v20, v6, v55
    v_fma_f32 v9, v20, v7, v87
    v_fma_f32 v8, -v21, v7, v8
    v_fma_f32 v7, v21, v6, v9
    v_mov_b32 v6, v8
    buffer_store_dword v6, v4, s[56:59], s67 offen
    buffer_store_dword v7, v5, s[56:59], s67 offen
    s_add_u32 s67, s67, 5120
    v_fma_f32 v8, v20, v6, v56
    v_fma_f32 v9, v20, v7, v88
    v_fma_f32 v8, -v21, v7, v8
    v_fma_f32 v7, v21, v6, v9
    v_mov_b32 v6, v8
    buffer_store_dword v6, v4, s[56:59], s67 offen
    buffer_store_dword v7, v5, s[56:59], s67 offen
    s_add_u32 s67, s67, 5120
    v_fma_f32 v8, v20, v6, v57
    v_fma_f32 v9, v20, v7, v89
    v_fma_f32 v8, -v21, v7, v8
    v_fma_f32 v7, v21, v6, v9
    v_mov_b32 v6, v8
    buffer_store_dword v6, v4, s[56:59], s67 offen
    buffer_store_dword v7, v5, s[56:59], s67 offen
    s_add_u32 s67, s67, 5120
    v_fma_f32 v8, v20, v6, v58
    v_fma_f32 v9, v20, v7, v90
    v_fma_f32 v8, -v21, v7, v8
    v_fma_f32 v7, v21, v6, v9
    v_mov_b32 v6, v8
    buffer_store_dword v6, v4, s[56:59], s67 offen
    buffer_store_dword v7, v5, s[56:59], s67 offen
    s_add_u32 s67, s67, 5120
    v_fma_f32 v8, v20, v6, v59
    v_fma_f32 v9, v20, v7, v91
    v_fma_f32 v8, -v21, v7, v8
    v_fma_f32 v7, v21, v6, v9
    v_mov_b32 v6, v8
    buffer_store_dword v6, v4, s[56:59], s67 offen
    buffer_store_dword v7, v5, s[56:59], s67 offen
    s_add_u32 s67, s67, 5120
    v_fma_f32 v8, v20, v6, v60
    v_fma_f32 v9, v20, v7, v92
    v_fma_f32 v8, -v21, v7, v8
    v_fma_f32 v7, v21, v6, v9
    v_mov_b32 v6, v8
    buffer_store_dword v6, v4, s[56:59], s67 offen
    buffer_store_dword v7, v5, s[56:59], s67 offen
    s_add_u32 s67, s67, 5120
    v_fma_f32 v8, v20, v6, v61
    v_fma_f32 v9, v20, v7, v93
    v_fma_f32 v8, -v21, v7, v8
    v_fma_f32 v7, v21, v6, v9
    v_mov_b32 v6, v8
    buffer_store_dword v6, v4, s[56:59], s67 offen
    buffer_store_dword v7, v5, s[56:59], s67 offen
    s_add_u32 s67, s67, 5120
    v_fma_f32 v8, v20, v6, v62
    v_fma_f32 v9, v20, v7, v94
    v_fma_f32 v8, -v21, v7, v8
    v_fma_f32 v7, v21, v6, v9
    v_mov_b32 v6, v8
    buffer_store_dword v6, v4, s[56:59], s67 offen
    buffer_store_dword v7, v5, s[56:59], s67 offen
    s_add_u32 s67, s67, 5120
    v_fma_f32 v8, v20, v6, v63
    v_fma_f32 v9, v20, v7, v95
    v_fma_f32 v8, -v21, v7, v8
    v_fma_f32 v7, v21, v6, v9
    v_mov_b32 v6, v8
    buffer_store_dword v6, v4, s[56:59], s67 offen
    buffer_store_dword v7, v5, s[56:59], s67 offen
    s_add_u32 s67, s67, 5120
    s_mul_i32 s67, s65, 5120
    buffer_store_dword v6, v4, s[60:63], s67 offen
    buffer_store_dword v7, v5, s[60:63], s67 offen
    s_branch K1_END
K1_FFN:
    s_sub_u32 s42, s2, 160
    s_lshr_b32 s42, s42, 4
    s_lshl_b32 s43, s42, 7
    s_mov_b32 s12, s34
    s_mov_b32 s13, s35
    s_mov_b32 s14, 2211840
    s_mov_b32 s15, 0x00020000
    v_lshrrev_b32 v1, 4, v0
    v_mul_u32_u24 v1, 3456, v1
    v_and_b32 v2, 15, v0
    v_lshl_add_u32 v1, v2, 4, v1
    s_lshl_b32 s44, s43, 1
    v_add_u32 v14, s44, v1
    v_add_u32 v15, 55296, v14
    v_add_u32 v16, 110592, v14
    v_add_u32 v17, 165888, v14
    s_mov_b32 s90, 0
    s_mov_b32 s91, 0
    buffer_load_dwordx4 v[20:23], v10, s[8:11], s90 offen
    buffer_load_dwordx4 v[24:27], v11, s[8:11], s90 offen
    buffer_load_dwordx4 v[28:31], v12, s[8:11], s90 offen
    buffer_load_dwordx4 v[32:35], v13, s[8:11], s90 offen
    buffer_load_dwordx4 v[36:39], v14, s[12:15], s91 offen
    buffer_load_dwordx4 v[40:43], v15, s[12:15], s91 offen
    buffer_load_dwordx4 v[44:47], v16, s[12:15], s91 offen
    buffer_load_dwordx4 v[48:51], v17, s[12:15], s91 offen
    s_waitcnt vmcnt(0)
    ds_write_b128 v4, v[20:23] offset:0
    ds_write_b128 v4, v[24:27] offset:4608
    ds_write_b128 v4, v[28:31] offset:9216
    ds_write_b128 v4, v[32:35] offset:13824
    ds_write_b128 v6, v[36:39] offset:0
    ds_write_b128 v6, v[40:43] offset:5120
    ds_write_b128 v6, v[44:47] offset:10240
    ds_write_b128 v6, v[48:51] offset:15360
    s_waitcnt lgkmcnt(0)
    s_barrier
    s_mov_b32 s90, 128
    s_mov_b32 s91, 221184
    buffer_load_dwordx4 v[20:23], v10, s[8:11], s90 offen
    buffer_load_dwordx4 v[24:27], v11, s[8:11], s90 offen
    buffer_load_dwordx4 v[28:31], v12, s[8:11], s90 offen
    buffer_load_dwordx4 v[32:35], v13, s[8:11], s90 offen
    buffer_load_dwordx4 v[36:39], v14, s[12:15], s91 offen
    buffer_load_dwordx4 v[40:43], v15, s[12:15], s91 offen
    buffer_load_dwordx4 v[44:47], v16, s[12:15], s91 offen
    buffer_load_dwordx4 v[48:51], v17, s[12:15], s91 offen
    ds_read_b128 v[52:55], v7 offset:0
    ds_read_b128 v[56:59], v7 offset:4608
    ds_read_b64_tr_b16 v[68:69], v9 offset:0
    ds_read_b64_tr_b16 v[70:71], v9 offset:1280
    ds_read_b64_tr_b16 v[72:73], v9 offset:64
    ds_read_b64_tr_b16 v[74:75], v9 offset:1344
    ds_read_b128 v[60:63], v7 offset:32
    ds_read_b128 v[64:67], v7 offset:4640
    ds_read_b64_tr_b16 v[76:77], v9 offset:5120
    ds_read_b64_tr_b16 v[78:79], v9 offset:6400
    ds_read_b64_tr_b16 v[80:81], v9 offset:5184
    ds_read_b64_tr_b16 v[82:83], v9 offset:6464
    s_waitcnt lgkmcnt(6)
    v_mfma_f32_32x32x16_bf16 v[96:111], v[68:71], v[52:55], v[96:111]
    v_mfma_f32_32x32x16_bf16 v[112:127], v[72:75], v[52:55], v[112:127]
    v_mfma_f32_32x32x16_bf16 v[128:143], v[68:71], v[56:59], v[128:143]
    v_mfma_f32_32x32x16_bf16 v[144:159], v[72:75], v[56:59], v[144:159]
    ds_read_b128 v[52:55], v7 offset:64
    ds_read_b128 v[56:59], v7 offset:4672
    ds_read_b64_tr_b16 v[68:69], v9 offset:10240
    ds_read_b64_tr_b16 v[70:71], v9 offset:11520
    ds_read_b64_tr_b16 v[72:73], v9 offset:10304
    ds_read_b64_tr_b16 v[74:75], v9 offset:11584
    s_waitcnt lgkmcnt(6)
    v_mfma_f32_32x32x16_bf16 v[96:111], v[76:79], v[60:63], v[96:111]
    v_mfma_f32_32x32x16_bf16 v[112:127], v[80:83], v[60:63], v[112:127]
    v_mfma_f32_32x32x16_bf16 v[128:143], v[76:79], v[64:67], v[128:143]
    v_mfma_f32_32x32x16_bf16 v[144:159], v[80:83], v[64:67], v[144:159]
    ds_read_b128 v[60:63], v7 offset:96
    ds_read_b128 v[64:67], v7 offset:4704
    ds_read_b64_tr_b16 v[76:77], v9 offset:15360
    ds_read_b64_tr_b16 v[78:79], v9 offset:16640
    ds_read_b64_tr_b16 v[80:81], v9 offset:15424
    ds_read_b64_tr_b16 v[82:83], v9 offset:16704
    s_waitcnt lgkmcnt(6)
    v_mfma_f32_32x32x16_bf16 v[96:111], v[68:71], v[52:55], v[96:111]
    v_mfma_f32_32x32x16_bf16 v[112:127], v[72:75], v[52:55], v[112:127]
    v_mfma_f32_32x32x16_bf16 v[128:143], v[68:71], v[56:59], v[128:143]
    v_mfma_f32_32x32x16_bf16 v[144:159], v[72:75], v[56:59], v[144:159]
    s_waitcnt lgkmcnt(0)
    v_mfma_f32_32x32x16_bf16 v[96:111], v[76:79], v[60:63], v[96:111]
    v_mfma_f32_32x32x16_bf16 v[112:127], v[80:83], v[60:63], v[112:127]
    v_mfma_f32_32x32x16_bf16 v[128:143], v[76:79], v[64:67], v[128:143]
    v_mfma_f32_32x32x16_bf16 v[144:159], v[80:83], v[64:67], v[144:159]
    s_waitcnt vmcnt(0)
    ds_write_b128 v4, v[20:23] offset:38912
    ds_write_b128 v4, v[24:27] offset:43520
    ds_write_b128 v4, v[28:31] offset:48128
    ds_write_b128 v4, v[32:35] offset:52736
    ds_write_b128 v6, v[36:39] offset:38912
    ds_write_b128 v6, v[40:43] offset:44032
    ds_write_b128 v6, v[44:47] offset:49152
    ds_write_b128 v6, v[48:51] offset:54272
    s_waitcnt lgkmcnt(0)
    s_barrier
    s_mov_b32 s90, 256
    s_mov_b32 s91, 442368
    buffer_load_dwordx4 v[20:23], v10, s[8:11], s90 offen
    buffer_load_dwordx4 v[24:27], v11, s[8:11], s90 offen
    buffer_load_dwordx4 v[28:31], v12, s[8:11], s90 offen
    buffer_load_dwordx4 v[32:35], v13, s[8:11], s90 offen
    buffer_load_dwordx4 v[36:39], v14, s[12:15], s91 offen
    buffer_load_dwordx4 v[40:43], v15, s[12:15], s91 offen
    buffer_load_dwordx4 v[44:47], v16, s[12:15], s91 offen
    buffer_load_dwordx4 v[48:51], v17, s[12:15], s91 offen
    ds_read_b128 v[52:55], v7 offset:38912
    ds_read_b128 v[56:59], v7 offset:43520
    ds_read_b64_tr_b16 v[68:69], v9 offset:38912
    ds_read_b64_tr_b16 v[70:71], v9 offset:40192
    ds_read_b64_tr_b16 v[72:73], v9 offset:38976
    ds_read_b64_tr_b16 v[74:75], v9 offset:40256
    ds_read_b128 v[60:63], v7 offset:38944
    ds_read_b128 v[64:67], v7 offset:43552
    ds_read_b64_tr_b16 v[76:77], v9 offset:44032
    ds_read_b64_tr_b16 v[78:79], v9 offset:45312
    ds_read_b64_tr_b16 v[80:81], v9 offset:44096
    ds_read_b64_tr_b16 v[82:83], v9 offset:45376
    s_waitcnt lgkmcnt(6)
    v_mfma_f32_32x32x16_bf16 v[96:111], v[68:71], v[52:55], v[96:111]
    v_mfma_f32_32x32x16_bf16 v[112:127], v[72:75], v[52:55], v[112:127]
    v_mfma_f32_32x32x16_bf16 v[128:143], v[68:71], v[56:59], v[128:143]
    v_mfma_f32_32x32x16_bf16 v[144:159], v[72:75], v[56:59], v[144:159]
    ds_read_b128 v[52:55], v7 offset:38976
    ds_read_b128 v[56:59], v7 offset:43584
    ds_read_b64_tr_b16 v[68:69], v9 offset:49152
    ds_read_b64_tr_b16 v[70:71], v9 offset:50432
    ds_read_b64_tr_b16 v[72:73], v9 offset:49216
    ds_read_b64_tr_b16 v[74:75], v9 offset:50496
    s_waitcnt lgkmcnt(6)
    v_mfma_f32_32x32x16_bf16 v[96:111], v[76:79], v[60:63], v[96:111]
    v_mfma_f32_32x32x16_bf16 v[112:127], v[80:83], v[60:63], v[112:127]
    v_mfma_f32_32x32x16_bf16 v[128:143], v[76:79], v[64:67], v[128:143]
    v_mfma_f32_32x32x16_bf16 v[144:159], v[80:83], v[64:67], v[144:159]
    ds_read_b128 v[60:63], v7 offset:39008
    ds_read_b128 v[64:67], v7 offset:43616
    ds_read_b64_tr_b16 v[76:77], v9 offset:54272
    ds_read_b64_tr_b16 v[78:79], v9 offset:55552
    ds_read_b64_tr_b16 v[80:81], v9 offset:54336
    ds_read_b64_tr_b16 v[82:83], v9 offset:55616
    s_waitcnt lgkmcnt(6)
    v_mfma_f32_32x32x16_bf16 v[96:111], v[68:71], v[52:55], v[96:111]
    v_mfma_f32_32x32x16_bf16 v[112:127], v[72:75], v[52:55], v[112:127]
    v_mfma_f32_32x32x16_bf16 v[128:143], v[68:71], v[56:59], v[128:143]
    v_mfma_f32_32x32x16_bf16 v[144:159], v[72:75], v[56:59], v[144:159]
    s_waitcnt lgkmcnt(0)
    v_mfma_f32_32x32x16_bf16 v[96:111], v[76:79], v[60:63], v[96:111]
    v_mfma_f32_32x32x16_bf16 v[112:127], v[80:83], v[60:63], v[112:127]
    v_mfma_f32_32x32x16_bf16 v[128:143], v[76:79], v[64:67], v[128:143]
    v_mfma_f32_32x32x16_bf16 v[144:159], v[80:83], v[64:67], v[144:159]
    s_waitcnt vmcnt(0)
    ds_write_b128 v4, v[20:23] offset:0
    ds_write_b128 v4, v[24:27] offset:4608
    ds_write_b128 v4, v[28:31] offset:9216
    ds_write_b128 v4, v[32:35] offset:13824
    ds_write_b128 v6, v[36:39] offset:0
    ds_write_b128 v6, v[40:43] offset:5120
    ds_write_b128 v6, v[44:47] offset:10240
    ds_write_b128 v6, v[48:51] offset:15360
    s_waitcnt lgkmcnt(0)
    s_barrier
    s_mov_b32 s90, 384
    s_mov_b32 s91, 663552
    buffer_load_dwordx4 v[20:23], v10, s[8:11], s90 offen
    buffer_load_dwordx4 v[24:27], v11, s[8:11], s90 offen
    buffer_load_dwordx4 v[28:31], v12, s[8:11], s90 offen
    buffer_load_dwordx4 v[32:35], v13, s[8:11], s90 offen
    buffer_load_dwordx4 v[36:39], v14, s[12:15], s91 offen
    buffer_load_dwordx4 v[40:43], v15, s[12:15], s91 offen
    buffer_load_dwordx4 v[44:47], v16, s[12:15], s91 offen
    buffer_load_dwordx4 v[48:51], v17, s[12:15], s91 offen
    ds_read_b128 v[52:55], v7 offset:0
    ds_read_b128 v[56:59], v7 offset:4608
    ds_read_b64_tr_b16 v[68:69], v9 offset:0
    ds_read_b64_tr_b16 v[70:71], v9 offset:1280
    ds_read_b64_tr_b16 v[72:73], v9 offset:64
    ds_read_b64_tr_b16 v[74:75], v9 offset:1344
    ds_read_b128 v[60:63], v7 offset:32
    ds_read_b128 v[64:67], v7 offset:4640
    ds_read_b64_tr_b16 v[76:77], v9 offset:5120
    ds_read_b64_tr_b16 v[78:79], v9 offset:6400
    ds_read_b64_tr_b16 v[80:81], v9 offset:5184
    ds_read_b64_tr_b16 v[82:83], v9 offset:6464
    s_waitcnt lgkmcnt(6)
    v_mfma_f32_32x32x16_bf16 v[96:111], v[68:71], v[52:55], v[96:111]
    v_mfma_f32_32x32x16_bf16 v[112:127], v[72:75], v[52:55], v[112:127]
    v_mfma_f32_32x32x16_bf16 v[128:143], v[68:71], v[56:59], v[128:143]
    v_mfma_f32_32x32x16_bf16 v[144:159], v[72:75], v[56:59], v[144:159]
    ds_read_b128 v[52:55], v7 offset:64
    ds_read_b128 v[56:59], v7 offset:4672
    ds_read_b64_tr_b16 v[68:69], v9 offset:10240
    ds_read_b64_tr_b16 v[70:71], v9 offset:11520
    ds_read_b64_tr_b16 v[72:73], v9 offset:10304
    ds_read_b64_tr_b16 v[74:75], v9 offset:11584
    s_waitcnt lgkmcnt(6)
    v_mfma_f32_32x32x16_bf16 v[96:111], v[76:79], v[60:63], v[96:111]
    v_mfma_f32_32x32x16_bf16 v[112:127], v[80:83], v[60:63], v[112:127]
    v_mfma_f32_32x32x16_bf16 v[128:143], v[76:79], v[64:67], v[128:143]
    v_mfma_f32_32x32x16_bf16 v[144:159], v[80:83], v[64:67], v[144:159]
    ds_read_b128 v[60:63], v7 offset:96
    ds_read_b128 v[64:67], v7 offset:4704
    ds_read_b64_tr_b16 v[76:77], v9 offset:15360
    ds_read_b64_tr_b16 v[78:79], v9 offset:16640
    ds_read_b64_tr_b16 v[80:81], v9 offset:15424
    ds_read_b64_tr_b16 v[82:83], v9 offset:16704
    s_waitcnt lgkmcnt(6)
    v_mfma_f32_32x32x16_bf16 v[96:111], v[68:71], v[52:55], v[96:111]
    v_mfma_f32_32x32x16_bf16 v[112:127], v[72:75], v[52:55], v[112:127]
    v_mfma_f32_32x32x16_bf16 v[128:143], v[68:71], v[56:59], v[128:143]
    v_mfma_f32_32x32x16_bf16 v[144:159], v[72:75], v[56:59], v[144:159]
    s_waitcnt lgkmcnt(0)
    v_mfma_f32_32x32x16_bf16 v[96:111], v[76:79], v[60:63], v[96:111]
    v_mfma_f32_32x32x16_bf16 v[112:127], v[80:83], v[60:63], v[112:127]
    v_mfma_f32_32x32x16_bf16 v[128:143], v[76:79], v[64:67], v[128:143]
    v_mfma_f32_32x32x16_bf16 v[144:159], v[80:83], v[64:67], v[144:159]
    s_waitcnt vmcnt(0)
    ds_write_b128 v4, v[20:23] offset:38912
    ds_write_b128 v4, v[24:27] offset:43520
    ds_write_b128 v4, v[28:31] offset:48128
    ds_write_b128 v4, v[32:35] offset:52736
    ds_write_b128 v6, v[36:39] offset:38912
    ds_write_b128 v6, v[40:43] offset:44032
    ds_write_b128 v6, v[44:47] offset:49152
    ds_write_b128 v6, v[48:51] offset:54272
    s_waitcnt lgkmcnt(0)
    s_barrier
    s_mov_b32 s90, 512
    s_mov_b32 s91, 884736
    buffer_load_dwordx4 v[20:23], v10, s[8:11], s90 offen
    buffer_load_dwordx4 v[24:27], v11, s[8:11], s90 offen
    buffer_load_dwordx4 v[28:31], v12, s[8:11], s90 offen
    buffer_load_dwordx4 v[32:35], v13, s[8:11], s90 offen
    buffer_load_dwordx4 v[36:39], v14, s[12:15], s91 offen
    buffer_load_dwordx4 v[40:43], v15, s[12:15], s91 offen
    buffer_load_dwordx4 v[44:47], v16, s[12:15], s91 offen
    buffer_load_dwordx4 v[48:51], v17, s[12:15], s91 offen
    ds_read_b128 v[52:55], v7 offset:38912
    ds_read_b128 v[56:59], v7 offset:43520
    ds_read_b64_tr_b16 v[68:69], v9 offset:38912
    ds_read_b64_tr_b16 v[70:71], v9 offset:40192
    ds_read_b64_tr_b16 v[72:73], v9 offset:38976
    ds_read_b64_tr_b16 v[74:75], v9 offset:40256
    ds_read_b128 v[60:63], v7 offset:38944
    ds_read_b128 v[64:67], v7 offset:43552
    ds_read_b64_tr_b16 v[76:77], v9 offset:44032
    ds_read_b64_tr_b16 v[78:79], v9 offset:45312
    ds_read_b64_tr_b16 v[80:81], v9 offset:44096
    ds_read_b64_tr_b16 v[82:83], v9 offset:45376
    s_waitcnt lgkmcnt(6)
    v_mfma_f32_32x32x16_bf16 v[96:111], v[68:71], v[52:55], v[96:111]
    v_mfma_f32_32x32x16_bf16 v[112:127], v[72:75], v[52:55], v[112:127]
    v_mfma_f32_32x32x16_bf16 v[128:143], v[68:71], v[56:59], v[128:143]
    v_mfma_f32_32x32x16_bf16 v[144:159], v[72:75], v[56:59], v[144:159]
    ds_read_b128 v[52:55], v7 offset:38976
    ds_read_b128 v[56:59], v7 offset:43584
    ds_read_b64_tr_b16 v[68:69], v9 offset:49152
    ds_read_b64_tr_b16 v[70:71], v9 offset:50432
    ds_read_b64_tr_b16 v[72:73], v9 offset:49216
    ds_read_b64_tr_b16 v[74:75], v9 offset:50496
    s_waitcnt lgkmcnt(6)
    v_mfma_f32_32x32x16_bf16 v[96:111], v[76:79], v[60:63], v[96:111]
    v_mfma_f32_32x32x16_bf16 v[112:127], v[80:83], v[60:63], v[112:127]
    v_mfma_f32_32x32x16_bf16 v[128:143], v[76:79], v[64:67], v[128:143]
    v_mfma_f32_32x32x16_bf16 v[144:159], v[80:83], v[64:67], v[144:159]
    ds_read_b128 v[60:63], v7 offset:39008
    ds_read_b128 v[64:67], v7 offset:43616
    ds_read_b64_tr_b16 v[76:77], v9 offset:54272
    ds_read_b64_tr_b16 v[78:79], v9 offset:55552
    ds_read_b64_tr_b16 v[80:81], v9 offset:54336
    ds_read_b64_tr_b16 v[82:83], v9 offset:55616
    s_waitcnt lgkmcnt(6)
    v_mfma_f32_32x32x16_bf16 v[96:111], v[68:71], v[52:55], v[96:111]
    v_mfma_f32_32x32x16_bf16 v[112:127], v[72:75], v[52:55], v[112:127]
    v_mfma_f32_32x32x16_bf16 v[128:143], v[68:71], v[56:59], v[128:143]
    v_mfma_f32_32x32x16_bf16 v[144:159], v[72:75], v[56:59], v[144:159]
    s_waitcnt lgkmcnt(0)
    v_mfma_f32_32x32x16_bf16 v[96:111], v[76:79], v[60:63], v[96:111]
    v_mfma_f32_32x32x16_bf16 v[112:127], v[80:83], v[60:63], v[112:127]
    v_mfma_f32_32x32x16_bf16 v[128:143], v[76:79], v[64:67], v[128:143]
    v_mfma_f32_32x32x16_bf16 v[144:159], v[80:83], v[64:67], v[144:159]
    s_waitcnt vmcnt(0)
    ds_write_b128 v4, v[20:23] offset:0
    ds_write_b128 v4, v[24:27] offset:4608
    ds_write_b128 v4, v[28:31] offset:9216
    ds_write_b128 v4, v[32:35] offset:13824
    ds_write_b128 v6, v[36:39] offset:0
    ds_write_b128 v6, v[40:43] offset:5120
    ds_write_b128 v6, v[44:47] offset:10240
    ds_write_b128 v6, v[48:51] offset:15360
    s_waitcnt lgkmcnt(0)
    s_barrier
    s_mov_b32 s90, 640
    s_mov_b32 s91, 1105920
    buffer_load_dwordx4 v[20:23], v10, s[8:11], s90 offen
    buffer_load_dwordx4 v[24:27], v11, s[8:11], s90 offen
    buffer_load_dwordx4 v[28:31], v12, s[8:11], s90 offen
    buffer_load_dwordx4 v[32:35], v13, s[8:11], s90 offen
    buffer_load_dwordx4 v[36:39], v14, s[12:15], s91 offen
    buffer_load_dwordx4 v[40:43], v15, s[12:15], s91 offen
    buffer_load_dwordx4 v[44:47], v16, s[12:15], s91 offen
    buffer_load_dwordx4 v[48:51], v17, s[12:15], s91 offen
    ds_read_b128 v[52:55], v7 offset:0
    ds_read_b128 v[56:59], v7 offset:4608
    ds_read_b64_tr_b16 v[68:69], v9 offset:0
    ds_read_b64_tr_b16 v[70:71], v9 offset:1280
    ds_read_b64_tr_b16 v[72:73], v9 offset:64
    ds_read_b64_tr_b16 v[74:75], v9 offset:1344
    ds_read_b128 v[60:63], v7 offset:32
    ds_read_b128 v[64:67], v7 offset:4640
    ds_read_b64_tr_b16 v[76:77], v9 offset:5120
    ds_read_b64_tr_b16 v[78:79], v9 offset:6400
    ds_read_b64_tr_b16 v[80:81], v9 offset:5184
    ds_read_b64_tr_b16 v[82:83], v9 offset:6464
    s_waitcnt lgkmcnt(6)
    v_mfma_f32_32x32x16_bf16 v[96:111], v[68:71], v[52:55], v[96:111]
    v_mfma_f32_32x32x16_bf16 v[112:127], v[72:75], v[52:55], v[112:127]
    v_mfma_f32_32x32x16_bf16 v[128:143], v[68:71], v[56:59], v[128:143]
    v_mfma_f32_32x32x16_bf16 v[144:159], v[72:75], v[56:59], v[144:159]
    ds_read_b128 v[52:55], v7 offset:64
    ds_read_b128 v[56:59], v7 offset:4672
    ds_read_b64_tr_b16 v[68:69], v9 offset:10240
    ds_read_b64_tr_b16 v[70:71], v9 offset:11520
    ds_read_b64_tr_b16 v[72:73], v9 offset:10304
    ds_read_b64_tr_b16 v[74:75], v9 offset:11584
    s_waitcnt lgkmcnt(6)
    v_mfma_f32_32x32x16_bf16 v[96:111], v[76:79], v[60:63], v[96:111]
    v_mfma_f32_32x32x16_bf16 v[112:127], v[80:83], v[60:63], v[112:127]
    v_mfma_f32_32x32x16_bf16 v[128:143], v[76:79], v[64:67], v[128:143]
    v_mfma_f32_32x32x16_bf16 v[144:159], v[80:83], v[64:67], v[144:159]
    ds_read_b128 v[60:63], v7 offset:96
    ds_read_b128 v[64:67], v7 offset:4704
    ds_read_b64_tr_b16 v[76:77], v9 offset:15360
    ds_read_b64_tr_b16 v[78:79], v9 offset:16640
    ds_read_b64_tr_b16 v[80:81], v9 offset:15424
    ds_read_b64_tr_b16 v[82:83], v9 offset:16704
    s_waitcnt lgkmcnt(6)
    v_mfma_f32_32x32x16_bf16 v[96:111], v[68:71], v[52:55], v[96:111]
    v_mfma_f32_32x32x16_bf16 v[112:127], v[72:75], v[52:55], v[112:127]
    v_mfma_f32_32x32x16_bf16 v[128:143], v[68:71], v[56:59], v[128:143]
    v_mfma_f32_32x32x16_bf16 v[144:159], v[72:75], v[56:59], v[144:159]
    s_waitcnt lgkmcnt(0)
    v_mfma_f32_32x32x16_bf16 v[96:111], v[76:79], v[60:63], v[96:111]
    v_mfma_f32_32x32x16_bf16 v[112:127], v[80:83], v[60:63], v[112:127]
    v_mfma_f32_32x32x16_bf16 v[128:143], v[76:79], v[64:67], v[128:143]
    v_mfma_f32_32x32x16_bf16 v[144:159], v[80:83], v[64:67], v[144:159]
    s_waitcnt vmcnt(0)
    ds_write_b128 v4, v[20:23] offset:38912
    ds_write_b128 v4, v[24:27] offset:43520
    ds_write_b128 v4, v[28:31] offset:48128
    ds_write_b128 v4, v[32:35] offset:52736
    ds_write_b128 v6, v[36:39] offset:38912
    ds_write_b128 v6, v[40:43] offset:44032
    ds_write_b128 v6, v[44:47] offset:49152
    ds_write_b128 v6, v[48:51] offset:54272
    s_waitcnt lgkmcnt(0)
    s_barrier
    s_mov_b32 s90, 768
    s_mov_b32 s91, 1327104
    buffer_load_dwordx4 v[20:23], v10, s[8:11], s90 offen
    buffer_load_dwordx4 v[24:27], v11, s[8:11], s90 offen
    buffer_load_dwordx4 v[28:31], v12, s[8:11], s90 offen
    buffer_load_dwordx4 v[32:35], v13, s[8:11], s90 offen
    buffer_load_dwordx4 v[36:39], v14, s[12:15], s91 offen
    buffer_load_dwordx4 v[40:43], v15, s[12:15], s91 offen
    buffer_load_dwordx4 v[44:47], v16, s[12:15], s91 offen
    buffer_load_dwordx4 v[48:51], v17, s[12:15], s91 offen
    ds_read_b128 v[52:55], v7 offset:38912
    ds_read_b128 v[56:59], v7 offset:43520
    ds_read_b64_tr_b16 v[68:69], v9 offset:38912
    ds_read_b64_tr_b16 v[70:71], v9 offset:40192
    ds_read_b64_tr_b16 v[72:73], v9 offset:38976
    ds_read_b64_tr_b16 v[74:75], v9 offset:40256
    ds_read_b128 v[60:63], v7 offset:38944
    ds_read_b128 v[64:67], v7 offset:43552
    ds_read_b64_tr_b16 v[76:77], v9 offset:44032
    ds_read_b64_tr_b16 v[78:79], v9 offset:45312
    ds_read_b64_tr_b16 v[80:81], v9 offset:44096
    ds_read_b64_tr_b16 v[82:83], v9 offset:45376
    s_waitcnt lgkmcnt(6)
    v_mfma_f32_32x32x16_bf16 v[96:111], v[68:71], v[52:55], v[96:111]
    v_mfma_f32_32x32x16_bf16 v[112:127], v[72:75], v[52:55], v[112:127]
    v_mfma_f32_32x32x16_bf16 v[128:143], v[68:71], v[56:59], v[128:143]
    v_mfma_f32_32x32x16_bf16 v[144:159], v[72:75], v[56:59], v[144:159]
    ds_read_b128 v[52:55], v7 offset:38976
    ds_read_b128 v[56:59], v7 offset:43584
    ds_read_b64_tr_b16 v[68:69], v9 offset:49152
    ds_read_b64_tr_b16 v[70:71], v9 offset:50432
    ds_read_b64_tr_b16 v[72:73], v9 offset:49216
    ds_read_b64_tr_b16 v[74:75], v9 offset:50496
    s_waitcnt lgkmcnt(6)
    v_mfma_f32_32x32x16_bf16 v[96:111], v[76:79], v[60:63], v[96:111]
    v_mfma_f32_32x32x16_bf16 v[112:127], v[80:83], v[60:63], v[112:127]
    v_mfma_f32_32x32x16_bf16 v[128:143], v[76:79], v[64:67], v[128:143]
    v_mfma_f32_32x32x16_bf16 v[144:159], v[80:83], v[64:67], v[144:159]
    ds_read_b128 v[60:63], v7 offset:39008
    ds_read_b128 v[64:67], v7 offset:43616
    ds_read_b64_tr_b16 v[76:77], v9 offset:54272
    ds_read_b64_tr_b16 v[78:79], v9 offset:55552
    ds_read_b64_tr_b16 v[80:81], v9 offset:54336
    ds_read_b64_tr_b16 v[82:83], v9 offset:55616
    s_waitcnt lgkmcnt(6)
    v_mfma_f32_32x32x16_bf16 v[96:111], v[68:71], v[52:55], v[96:111]
    v_mfma_f32_32x32x16_bf16 v[112:127], v[72:75], v[52:55], v[112:127]
    v_mfma_f32_32x32x16_bf16 v[128:143], v[68:71], v[56:59], v[128:143]
    v_mfma_f32_32x32x16_bf16 v[144:159], v[72:75], v[56:59], v[144:159]
    s_waitcnt lgkmcnt(0)
    v_mfma_f32_32x32x16_bf16 v[96:111], v[76:79], v[60:63], v[96:111]
    v_mfma_f32_32x32x16_bf16 v[112:127], v[80:83], v[60:63], v[112:127]
    v_mfma_f32_32x32x16_bf16 v[128:143], v[76:79], v[64:67], v[128:143]
    v_mfma_f32_32x32x16_bf16 v[144:159], v[80:83], v[64:67], v[144:159]
    s_waitcnt vmcnt(0)
    ds_write_b128 v4, v[20:23] offset:0
    ds_write_b128 v4, v[24:27] offset:4608
    ds_write_b128 v4, v[28:31] offset:9216
    ds_write_b128 v4, v[32:35] offset:13824
    ds_write_b128 v6, v[36:39] offset:0
    ds_write_b128 v6, v[40:43] offset:5120
    ds_write_b128 v6, v[44:47] offset:10240
    ds_write_b128 v6, v[48:51] offset:15360
    s_waitcnt lgkmcnt(0)
    s_barrier
    s_mov_b32 s90, 896
    s_mov_b32 s91, 1548288
    buffer_load_dwordx4 v[20:23], v10, s[8:11], s90 offen
    buffer_load_dwordx4 v[24:27], v11, s[8:11], s90 offen
    buffer_load_dwordx4 v[28:31], v12, s[8:11], s90 offen
    buffer_load_dwordx4 v[32:35], v13, s[8:11], s90 offen
    buffer_load_dwordx4 v[36:39], v14, s[12:15], s91 offen
    buffer_load_dwordx4 v[40:43], v15, s[12:15], s91 offen
    buffer_load_dwordx4 v[44:47], v16, s[12:15], s91 offen
    buffer_load_dwordx4 v[48:51], v17, s[12:15], s91 offen
    ds_read_b128 v[52:55], v7 offset:0
    ds_read_b128 v[56:59], v7 offset:4608
    ds_read_b64_tr_b16 v[68:69], v9 offset:0
    ds_read_b64_tr_b16 v[70:71], v9 offset:1280
    ds_read_b64_tr_b16 v[72:73], v9 offset:64
    ds_read_b64_tr_b16 v[74:75], v9 offset:1344
    ds_read_b128 v[60:63], v7 offset:32
    ds_read_b128 v[64:67], v7 offset:4640
    ds_read_b64_tr_b16 v[76:77], v9 offset:5120
    ds_read_b64_tr_b16 v[78:79], v9 offset:6400
    ds_read_b64_tr_b16 v[80:81], v9 offset:5184
    ds_read_b64_tr_b16 v[82:83], v9 offset:6464
    s_waitcnt lgkmcnt(6)
    v_mfma_f32_32x32x16_bf16 v[96:111], v[68:71], v[52:55], v[96:111]
    v_mfma_f32_32x32x16_bf16 v[112:127], v[72:75], v[52:55], v[112:127]
    v_mfma_f32_32x32x16_bf16 v[128:143], v[68:71], v[56:59], v[128:143]
    v_mfma_f32_32x32x16_bf16 v[144:159], v[72:75], v[56:59], v[144:159]
    ds_read_b128 v[52:55], v7 offset:64
    ds_read_b128 v[56:59], v7 offset:4672
    ds_read_b64_tr_b16 v[68:69], v9 offset:10240
    ds_read_b64_tr_b16 v[70:71], v9 offset:11520
    ds_read_b64_tr_b16 v[72:73], v9 offset:10304
    ds_read_b64_tr_b16 v[74:75], v9 offset:11584
    s_waitcnt lgkmcnt(6)
    v_mfma_f32_32x32x16_bf16 v[96:111], v[76:79], v[60:63], v[96:111]
    v_mfma_f32_32x32x16_bf16 v[112:127], v[80:83], v[60:63], v[112:127]
    v_mfma_f32_32x32x16_bf16 v[128:143], v[76:79], v[64:67], v[128:143]
    v_mfma_f32_32x32x16_bf16 v[144:159], v[80:83], v[64:67], v[144:159]
    ds_read_b128 v[60:63], v7 offset:96
    ds_read_b128 v[64:67], v7 offset:4704
    ds_read_b64_tr_b16 v[76:77], v9 offset:15360
    ds_read_b64_tr_b16 v[78:79], v9 offset:16640
    ds_read_b64_tr_b16 v[80:81], v9 offset:15424
    ds_read_b64_tr_b16 v[82:83], v9 offset:16704
    s_waitcnt lgkmcnt(6)
    v_mfma_f32_32x32x16_bf16 v[96:111], v[68:71], v[52:55], v[96:111]
    v_mfma_f32_32x32x16_bf16 v[112:127], v[72:75], v[52:55], v[112:127]
    v_mfma_f32_32x32x16_bf16 v[128:143], v[68:71], v[56:59], v[128:143]
    v_mfma_f32_32x32x16_bf16 v[144:159], v[72:75], v[56:59], v[144:159]
    s_waitcnt lgkmcnt(0)
    v_mfma_f32_32x32x16_bf16 v[96:111], v[76:79], v[60:63], v[96:111]
    v_mfma_f32_32x32x16_bf16 v[112:127], v[80:83], v[60:63], v[112:127]
    v_mfma_f32_32x32x16_bf16 v[128:143], v[76:79], v[64:67], v[128:143]
    v_mfma_f32_32x32x16_bf16 v[144:159], v[80:83], v[64:67], v[144:159]
    s_waitcnt vmcnt(0)
    ds_write_b128 v4, v[20:23] offset:38912
    ds_write_b128 v4, v[24:27] offset:43520
    ds_write_b128 v4, v[28:31] offset:48128
    ds_write_b128 v4, v[32:35] offset:52736
    ds_write_b128 v6, v[36:39] offset:38912
    ds_write_b128 v6, v[40:43] offset:44032
    ds_write_b128 v6, v[44:47] offset:49152
    ds_write_b128 v6, v[48:51] offset:54272
    s_waitcnt lgkmcnt(0)
    s_barrier
    s_mov_b32 s90, 1024
    s_mov_b32 s91, 1769472
    buffer_load_dwordx4 v[20:23], v10, s[8:11], s90 offen
    buffer_load_dwordx4 v[24:27], v11, s[8:11], s90 offen
    buffer_load_dwordx4 v[28:31], v12, s[8:11], s90 offen
    buffer_load_dwordx4 v[32:35], v13, s[8:11], s90 offen
    buffer_load_dwordx4 v[36:39], v14, s[12:15], s91 offen
    buffer_load_dwordx4 v[40:43], v15, s[12:15], s91 offen
    buffer_load_dwordx4 v[44:47], v16, s[12:15], s91 offen
    buffer_load_dwordx4 v[48:51], v17, s[12:15], s91 offen
    ds_read_b128 v[52:55], v7 offset:38912
    ds_read_b128 v[56:59], v7 offset:43520
    ds_read_b64_tr_b16 v[68:69], v9 offset:38912
    ds_read_b64_tr_b16 v[70:71], v9 offset:40192
    ds_read_b64_tr_b16 v[72:73], v9 offset:38976
    ds_read_b64_tr_b16 v[74:75], v9 offset:40256
    ds_read_b128 v[60:63], v7 offset:38944
    ds_read_b128 v[64:67], v7 offset:43552
    ds_read_b64_tr_b16 v[76:77], v9 offset:44032
    ds_read_b64_tr_b16 v[78:79], v9 offset:45312
    ds_read_b64_tr_b16 v[80:81], v9 offset:44096
    ds_read_b64_tr_b16 v[82:83], v9 offset:45376
    s_waitcnt lgkmcnt(6)
    v_mfma_f32_32x32x16_bf16 v[96:111], v[68:71], v[52:55], v[96:111]
    v_mfma_f32_32x32x16_bf16 v[112:127], v[72:75], v[52:55], v[112:127]
    v_mfma_f32_32x32x16_bf16 v[128:143], v[68:71], v[56:59], v[128:143]
    v_mfma_f32_32x32x16_bf16 v[144:159], v[72:75], v[56:59], v[144:159]
    ds_read_b128 v[52:55], v7 offset:38976
    ds_read_b128 v[56:59], v7 offset:43584
    ds_read_b64_tr_b16 v[68:69], v9 offset:49152
    ds_read_b64_tr_b16 v[70:71], v9 offset:50432
    ds_read_b64_tr_b16 v[72:73], v9 offset:49216
    ds_read_b64_tr_b16 v[74:75], v9 offset:50496
    s_waitcnt lgkmcnt(6)
    v_mfma_f32_32x32x16_bf16 v[96:111], v[76:79], v[60:63], v[96:111]
    v_mfma_f32_32x32x16_bf16 v[112:127], v[80:83], v[60:63], v[112:127]
    v_mfma_f32_32x32x16_bf16 v[128:143], v[76:79], v[64:67], v[128:143]
    v_mfma_f32_32x32x16_bf16 v[144:159], v[80:83], v[64:67], v[144:159]
    ds_read_b128 v[60:63], v7 offset:39008
    ds_read_b128 v[64:67], v7 offset:43616
    ds_read_b64_tr_b16 v[76:77], v9 offset:54272
    ds_read_b64_tr_b16 v[78:79], v9 offset:55552
    ds_read_b64_tr_b16 v[80:81], v9 offset:54336
    ds_read_b64_tr_b16 v[82:83], v9 offset:55616
    s_waitcnt lgkmcnt(6)
    v_mfma_f32_32x32x16_bf16 v[96:111], v[68:71], v[52:55], v[96:111]
    v_mfma_f32_32x32x16_bf16 v[112:127], v[72:75], v[52:55], v[112:127]
    v_mfma_f32_32x32x16_bf16 v[128:143], v[68:71], v[56:59], v[128:143]
    v_mfma_f32_32x32x16_bf16 v[144:159], v[72:75], v[56:59], v[144:159]
    s_waitcnt lgkmcnt(0)
    v_mfma_f32_32x32x16_bf16 v[96:111], v[76:79], v[60:63], v[96:111]
    v_mfma_f32_32x32x16_bf16 v[112:127], v[80:83], v[60:63], v[112:127]
    v_mfma_f32_32x32x16_bf16 v[128:143], v[76:79], v[64:67], v[128:143]
    v_mfma_f32_32x32x16_bf16 v[144:159], v[80:83], v[64:67], v[144:159]
    s_waitcnt vmcnt(0)
    ds_write_b128 v4, v[20:23] offset:0
    ds_write_b128 v4, v[24:27] offset:4608
    ds_write_b128 v4, v[28:31] offset:9216
    ds_write_b128 v4, v[32:35] offset:13824
    ds_write_b128 v6, v[36:39] offset:0
    ds_write_b128 v6, v[40:43] offset:5120
    ds_write_b128 v6, v[44:47] offset:10240
    ds_write_b128 v6, v[48:51] offset:15360
    s_waitcnt lgkmcnt(0)
    s_barrier
    s_mov_b32 s90, 1152
    s_mov_b32 s91, 1990656
    buffer_load_dwordx4 v[20:23], v10, s[8:11], s90 offen
    buffer_load_dwordx4 v[24:27], v11, s[8:11], s90 offen
    buffer_load_dwordx4 v[28:31], v12, s[8:11], s90 offen
    buffer_load_dwordx4 v[32:35], v13, s[8:11], s90 offen
    buffer_load_dwordx4 v[36:39], v14, s[12:15], s91 offen
    buffer_load_dwordx4 v[40:43], v15, s[12:15], s91 offen
    buffer_load_dwordx4 v[44:47], v16, s[12:15], s91 offen
    buffer_load_dwordx4 v[48:51], v17, s[12:15], s91 offen
    ds_read_b128 v[52:55], v7 offset:0
    ds_read_b128 v[56:59], v7 offset:4608
    ds_read_b64_tr_b16 v[68:69], v9 offset:0
    ds_read_b64_tr_b16 v[70:71], v9 offset:1280
    ds_read_b64_tr_b16 v[72:73], v9 offset:64
    ds_read_b64_tr_b16 v[74:75], v9 offset:1344
    ds_read_b128 v[60:63], v7 offset:32
    ds_read_b128 v[64:67], v7 offset:4640
    ds_read_b64_tr_b16 v[76:77], v9 offset:5120
    ds_read_b64_tr_b16 v[78:79], v9 offset:6400
    ds_read_b64_tr_b16 v[80:81], v9 offset:5184
    ds_read_b64_tr_b16 v[82:83], v9 offset:6464
    s_waitcnt lgkmcnt(6)
    v_mfma_f32_32x32x16_bf16 v[96:111], v[68:71], v[52:55], v[96:111]
    v_mfma_f32_32x32x16_bf16 v[112:127], v[72:75], v[52:55], v[112:127]
    v_mfma_f32_32x32x16_bf16 v[128:143], v[68:71], v[56:59], v[128:143]
    v_mfma_f32_32x32x16_bf16 v[144:159], v[72:75], v[56:59], v[144:159]
    ds_read_b128 v[52:55], v7 offset:64
    ds_read_b128 v[56:59], v7 offset:4672
    ds_read_b64_tr_b16 v[68:69], v9 offset:10240
    ds_read_b64_tr_b16 v[70:71], v9 offset:11520
    ds_read_b64_tr_b16 v[72:73], v9 offset:10304
    ds_read_b64_tr_b16 v[74:75], v9 offset:11584
    s_waitcnt lgkmcnt(6)
    v_mfma_f32_32x32x16_bf16 v[96:111], v[76:79], v[60:63], v[96:111]
    v_mfma_f32_32x32x16_bf16 v[112:127], v[80:83], v[60:63], v[112:127]
    v_mfma_f32_32x32x16_bf16 v[128:143], v[76:79], v[64:67], v[128:143]
    v_mfma_f32_32x32x16_bf16 v[144:159], v[80:83], v[64:67], v[144:159]
    ds_read_b128 v[60:63], v7 offset:96
    ds_read_b128 v[64:67], v7 offset:4704
    ds_read_b64_tr_b16 v[76:77], v9 offset:15360
    ds_read_b64_tr_b16 v[78:79], v9 offset:16640
    ds_read_b64_tr_b16 v[80:81], v9 offset:15424
    ds_read_b64_tr_b16 v[82:83], v9 offset:16704
    s_waitcnt lgkmcnt(6)
    v_mfma_f32_32x32x16_bf16 v[96:111], v[68:71], v[52:55], v[96:111]
    v_mfma_f32_32x32x16_bf16 v[112:127], v[72:75], v[52:55], v[112:127]
    v_mfma_f32_32x32x16_bf16 v[128:143], v[68:71], v[56:59], v[128:143]
    v_mfma_f32_32x32x16_bf16 v[144:159], v[72:75], v[56:59], v[144:159]
    s_waitcnt lgkmcnt(0)
    v_mfma_f32_32x32x16_bf16 v[96:111], v[76:79], v[60:63], v[96:111]
    v_mfma_f32_32x32x16_bf16 v[112:127], v[80:83], v[60:63], v[112:127]
    v_mfma_f32_32x32x16_bf16 v[128:143], v[76:79], v[64:67], v[128:143]
    v_mfma_f32_32x32x16_bf16 v[144:159], v[80:83], v[64:67], v[144:159]
    s_waitcnt vmcnt(0)
    ds_write_b128 v4, v[20:23] offset:38912
    ds_write_b128 v4, v[24:27] offset:43520
    ds_write_b128 v4, v[28:31] offset:48128
    ds_write_b128 v4, v[32:35] offset:52736
    ds_write_b128 v6, v[36:39] offset:38912
    ds_write_b128 v6, v[40:43] offset:44032
    ds_write_b128 v6, v[44:47] offset:49152
    ds_write_b128 v6, v[48:51] offset:54272
    s_waitcnt lgkmcnt(0)
    s_barrier
    ds_read_b128 v[52:55], v7 offset:38912
    ds_read_b128 v[56:59], v7 offset:43520
    ds_read_b64_tr_b16 v[68:69], v9 offset:38912
    ds_read_b64_tr_b16 v[70:71], v9 offset:40192
    ds_read_b64_tr_b16 v[72:73], v9 offset:38976
    ds_read_b64_tr_b16 v[74:75], v9 offset:40256
    ds_read_b128 v[60:63], v7 offset:38944
    ds_read_b128 v[64:67], v7 offset:43552
    ds_read_b64_tr_b16 v[76:77], v9 offset:44032
    ds_read_b64_tr_b16 v[78:79], v9 offset:45312
    ds_read_b64_tr_b16 v[80:81], v9 offset:44096
    ds_read_b64_tr_b16 v[82:83], v9 offset:45376
    s_waitcnt lgkmcnt(6)
    v_mfma_f32_32x32x16_bf16 v[96:111], v[68:71], v[52:55], v[96:111]
    v_mfma_f32_32x32x16_bf16 v[112:127], v[72:75], v[52:55], v[112:127]
    v_mfma_f32_32x32x16_bf16 v[128:143], v[68:71], v[56:59], v[128:143]
    v_mfma_f32_32x32x16_bf16 v[144:159], v[72:75], v[56:59], v[144:159]
    ds_read_b128 v[52:55], v7 offset:38976
    ds_read_b128 v[56:59], v7 offset:43584
    ds_read_b64_tr_b16 v[68:69], v9 offset:49152
    ds_read_b64_tr_b16 v[70:71], v9 offset:50432
    ds_read_b64_tr_b16 v[72:73], v9 offset:49216
    ds_read_b64_tr_b16 v[74:75], v9 offset:50496
    s_waitcnt lgkmcnt(6)
    v_mfma_f32_32x32x16_bf16 v[96:111], v[76:79], v[60:63], v[96:111]
    v_mfma_f32_32x32x16_bf16 v[112:127], v[80:83], v[60:63], v[112:127]
    v_mfma_f32_32x32x16_bf16 v[128:143], v[76:79], v[64:67], v[128:143]
    v_mfma_f32_32x32x16_bf16 v[144:159], v[80:83], v[64:67], v[144:159]
    ds_read_b128 v[60:63], v7 offset:39008
    ds_read_b128 v[64:67], v7 offset:43616
    ds_read_b64_tr_b16 v[76:77], v9 offset:54272
    ds_read_b64_tr_b16 v[78:79], v9 offset:55552
    ds_read_b64_tr_b16 v[80:81], v9 offset:54336
    ds_read_b64_tr_b16 v[82:83], v9 offset:55616
    s_waitcnt lgkmcnt(6)
    v_mfma_f32_32x32x16_bf16 v[96:111], v[68:71], v[52:55], v[96:111]
    v_mfma_f32_32x32x16_bf16 v[112:127], v[72:75], v[52:55], v[112:127]
    v_mfma_f32_32x32x16_bf16 v[128:143], v[68:71], v[56:59], v[128:143]
    v_mfma_f32_32x32x16_bf16 v[144:159], v[72:75], v[56:59], v[144:159]
    s_waitcnt lgkmcnt(0)
    v_mfma_f32_32x32x16_bf16 v[96:111], v[76:79], v[60:63], v[96:111]
    v_mfma_f32_32x32x16_bf16 v[112:127], v[80:83], v[60:63], v[112:127]
    v_mfma_f32_32x32x16_bf16 v[128:143], v[76:79], v[64:67], v[128:143]
    v_mfma_f32_32x32x16_bf16 v[144:159], v[80:83], v[64:67], v[144:159]
    s_barrier
    v_bfe_u32 v2, v0, 6, 1
    s_nop 1
    v_readfirstlane_b32 s45, v2
    s_nop 3
    s_lshl_b32 s45, s45, 6
    s_add_u32 s45, s45, s43
    s_cmp_ge_u32 s45, 1728
    s_cbranch_scc1 K1_END
    s_mov_b32 s56, s36
    s_mov_b32 s57, s37
    s_mov_b32 s58, 7077888
    s_mov_b32 s59, 0x00020000
    v_and_b32 v1, 31, v0
    v_lshrrev_b32 v2, 7, v0
    v_lshl_add_u32 v1, v2, 6, v1
    v_add_u32 v1, s41, v1
    v_mul_u32_u24 v1, 3456, v1
    v_bfe_u32 v2, v0, 5, 1
    v_lshl_add_u32 v1, v2, 3, v1
    s_lshl_b32 s45, s45, 1
    v_add_u32 v1, s45, v1
    v_add_u32 v2, 110592, v1
    s_nop 7
    s_nop 7
    v_max_f32 v96, 0, v96
    v_max_f32 v97, 0, v97
    v_max_f32 v98, 0, v98
    v_max_f32 v99, 0, v99
    v_cvt_pk_bf16_f32 v96, v96, v97
    v_cvt_pk_bf16_f32 v97, v98, v99
    buffer_store_dwordx2 v[96:97], v1, s[56:59], 0 offen offset:0
    v_max_f32 v100, 0, v100
    v_max_f32 v101, 0, v101
    v_max_f32 v102, 0, v102
    v_max_f32 v103, 0, v103
    v_cvt_pk_bf16_f32 v100, v100, v101
    v_cvt_pk_bf16_f32 v101, v102, v103
    buffer_store_dwordx2 v[100:101], v1, s[56:59], 0 offen offset:16
    v_max_f32 v104, 0, v104
    v_max_f32 v105, 0, v105
    v_max_f32 v106, 0, v106
    v_max_f32 v107, 0, v107
    v_cvt_pk_bf16_f32 v104, v104, v105
    v_cvt_pk_bf16_f32 v105, v106, v107
    buffer_store_dwordx2 v[104:105], v1, s[56:59], 0 offen offset:32
    v_max_f32 v108, 0, v108
    v_max_f32 v109, 0, v109
    v_max_f32 v110, 0, v110
    v_max_f32 v111, 0, v111
    v_cvt_pk_bf16_f32 v108, v108, v109
    v_cvt_pk_bf16_f32 v109, v110, v111
    buffer_store_dwordx2 v[108:109], v1, s[56:59], 0 offen offset:48
    v_max_f32 v112, 0, v112
    v_max_f32 v113, 0, v113
    v_max_f32 v114, 0, v114
    v_max_f32 v115, 0, v115
    v_cvt_pk_bf16_f32 v112, v112, v113
    v_cvt_pk_bf16_f32 v113, v114, v115
    buffer_store_dwordx2 v[112:113], v1, s[56:59], 0 offen offset:64
    v_max_f32 v116, 0, v116
    v_max_f32 v117, 0, v117
    v_max_f32 v118, 0, v118
    v_max_f32 v119, 0, v119
    v_cvt_pk_bf16_f32 v116, v116, v117
    v_cvt_pk_bf16_f32 v117, v118, v119
    buffer_store_dwordx2 v[116:117], v1, s[56:59], 0 offen offset:80
    v_max_f32 v120, 0, v120
    v_max_f32 v121, 0, v121
    v_max_f32 v122, 0, v122
    v_max_f32 v123, 0, v123
    v_cvt_pk_bf16_f32 v120, v120, v121
    v_cvt_pk_bf16_f32 v121, v122, v123
    buffer_store_dwordx2 v[120:121], v1, s[56:59], 0 offen offset:96
    v_max_f32 v124, 0, v124
    v_max_f32 v125, 0, v125
    v_max_f32 v126, 0, v126
    v_max_f32 v127, 0, v127
    v_cvt_pk_bf16_f32 v124, v124, v125
    v_cvt_pk_bf16_f32 v125, v126, v127
    buffer_store_dwordx2 v[124:125], v1, s[56:59], 0 offen offset:112
    v_max_f32 v128, 0, v128
    v_max_f32 v129, 0, v129
    v_max_f32 v130, 0, v130
    v_max_f32 v131, 0, v131
    v_cvt_pk_bf16_f32 v128, v128, v129
    v_cvt_pk_bf16_f32 v129, v130, v131
    buffer_store_dwordx2 v[128:129], v2, s[56:59], 0 offen offset:0
    v_max_f32 v132, 0, v132
    v_max_f32 v133, 0, v133
    v_max_f32 v134, 0, v134
    v_max_f32 v135, 0, v135
    v_cvt_pk_bf16_f32 v132, v132, v133
    v_cvt_pk_bf16_f32 v133, v134, v135
    buffer_store_dwordx2 v[132:133], v2, s[56:59], 0 offen offset:16
    v_max_f32 v136, 0, v136
    v_max_f32 v137, 0, v137
    v_max_f32 v138, 0, v138
    v_max_f32 v139, 0, v139
    v_cvt_pk_bf16_f32 v136, v136, v137
    v_cvt_pk_bf16_f32 v137, v138, v139
    buffer_store_dwordx2 v[136:137], v2, s[56:59], 0 offen offset:32
    v_max_f32 v140, 0, v140
    v_max_f32 v141, 0, v141
    v_max_f32 v142, 0, v142
    v_max_f32 v143, 0, v143
    v_cvt_pk_bf16_f32 v140, v140, v141
    v_cvt_pk_bf16_f32 v141, v142, v143
    buffer_store_dwordx2 v[140:141], v2, s[56:59], 0 offen offset:48
    v_max_f32 v144, 0, v144
    v_max_f32 v145, 0, v145
    v_max_f32 v146, 0, v146
    v_max_f32 v147, 0, v147
    v_cvt_pk_bf16_f32 v144, v144, v145
    v_cvt_pk_bf16_f32 v145, v146, v147
    buffer_store_dwordx2 v[144:145], v2, s[56:59], 0 offen offset:64
    v_max_f32 v148, 0, v148
    v_max_f32 v149, 0, v149
    v_max_f32 v150, 0, v150
    v_max_f32 v151, 0, v151
    v_cvt_pk_bf16_f32 v148, v148, v149
    v_cvt_pk_bf16_f32 v149, v150, v151
    buffer_store_dwordx2 v[148:149], v2, s[56:59], 0 offen offset:80
    v_max_f32 v152, 0, v152
    v_max_f32 v153, 0, v153
    v_max_f32 v154, 0, v154
    v_max_f32 v155, 0, v155
    v_cvt_pk_bf16_f32 v152, v152, v153
    v_cvt_pk_bf16_f32 v153, v154, v155
    buffer_store_dwordx2 v[152:153], v2, s[56:59], 0 offen offset:96
    v_max_f32 v156, 0, v156
    v_max_f32 v157, 0, v157
    v_max_f32 v158, 0, v158
    v_max_f32 v159, 0, v159
    v_cvt_pk_bf16_f32 v156, v156, v157
    v_cvt_pk_bf16_f32 v157, v158, v159
    buffer_store_dwordx2 v[156:157], v2, s[56:59], 0 offen offset:112
K1_END:
    s_endpgm
.globl k2_kernel
.p2align 8
.type k2_kernel,@function
k2_kernel:
    s_cmp_ge_u32 s2, 576
    s_cbranch_scc1 K2_END
    s_load_dwordx2 s[4:5], s[0:1], 0
    s_load_dwordx4 s[24:27], s[0:1], 8
    s_load_dwordx2 s[32:33], s[0:1], 56
    s_load_dwordx2 s[34:35], s[0:1], 96
    s_load_dwordx2 s[36:37], s[0:1], 120
    s_waitcnt lgkmcnt(0)
    s_cmp_ge_u32 s2, 320
    s_cbranch_scc1 K2_GATE
    s_mov_b32 s44, s24
    s_mov_b32 s45, s25
    s_mov_b32 s46, 1280
    s_mov_b32 s47, 0x00020000
    s_mov_b32 s48, s26
    s_mov_b32 s49, s27
    s_mov_b32 s50, 1280
    s_mov_b32 s51, 0x00020000
    s_mov_b32 s52, s32
    s_mov_b32 s53, s33
    s_mov_b32 s54, 1280
    s_mov_b32 s55, 0x00020000
    s_add_u32 s56, s36, 8388608
    s_addc_u32 s57, s37, 0
    s_mov_b32 s58, 10485760
    s_mov_b32 s59, 0x00020000
    s_add_u32 s60, s36, 20971520
    s_addc_u32 s61, s37, 0
    s_mov_b32 s62, 327680
    s_mov_b32 s63, 0x00020000
    s_add_u32 s64, s36, 22020096
    s_addc_u32 s65, s37, 0
    s_mov_b32 s66, 5242880
    s_mov_b32 s67, 0x00020000
    s_mul_hi_u32 s40, s2, 0x33333334
    s_mul_i32 s41, s40, 5
    s_sub_u32 s41, s2, s41
    s_lshl_b32 s41, s41, 7
    v_lshl_add_u32 v1, v0, 1, s41
    v_lshlrev_b32 v2, 1, v1
    buffer_load_ushort v20, v2, s[44:47], 0 offen
    buffer_load_ushort v21, v2, s[48:51], 0 offen
    buffer_load_ushort v22, v2, s[52:55], 0 offen
    s_waitcnt vmcnt(0)
    v_lshlrev_b32 v20, 16, v20
    v_lshlrev_b32 v21, 16, v21
    v_lshlrev_b32 v22, 16, v22
    v_mul_f32 v22, 0x3fb8aa3b, v22
    v_exp_f32 v22, v22
    s_nop 0
    v_cvt_pk_bf16_f32 v22, v22, v22
    v_lshlrev_b32 v22, 16, v22
    v_mul_f32 v23, v22, v20
    v_mul_f32 v24, v22, v21
    v_mul_f32 v23, 0x3fb8aa3b, v23
    v_exp_f32 v23, v23
    v_mul_f32 v24, 0.15915494, v24
    v_cos_f32 v25, v24
    v_sin_f32 v24, v24
    s_nop 0
    v_mul_f32 v10, v23, v25
    v_mul_f32 v11, v23, v24
    v_add_f32 v23, -1.0, v10
    v_mul_f32 v24, v20, v20
    v_fmac_f32 v24, v21, v21
    v_rcp_f32 v24, v24
    v_mul_f32 v25, v23, v20
    v_fmac_f32 v25, v11, v21
    v_mul_f32 v13, v11, v20
    v_fma_f32 v13, -v23, v21, v13
    v_mul_f32 v12, v25, v24
    v_mul_f32 v13, v13, v24
    v_add_u32 v2, 2, v2
    buffer_load_ushort v20, v2, s[44:47], 0 offen
    buffer_load_ushort v21, v2, s[48:51], 0 offen
    buffer_load_ushort v22, v2, s[52:55], 0 offen
    s_waitcnt vmcnt(0)
    v_lshlrev_b32 v20, 16, v20
    v_lshlrev_b32 v21, 16, v21
    v_lshlrev_b32 v22, 16, v22
    v_mul_f32 v22, 0x3fb8aa3b, v22
    v_exp_f32 v22, v22
    s_nop 0
    v_cvt_pk_bf16_f32 v22, v22, v22
    v_lshlrev_b32 v22, 16, v22
    v_mul_f32 v23, v22, v20
    v_mul_f32 v24, v22, v21
    v_mul_f32 v23, 0x3fb8aa3b, v23
    v_exp_f32 v23, v23
    v_mul_f32 v24, 0.15915494, v24
    v_cos_f32 v25, v24
    v_sin_f32 v24, v24
    s_nop 0
    v_mul_f32 v14, v23, v25
    v_mul_f32 v15, v23, v24
    v_add_f32 v23, -1.0, v14
    v_mul_f32 v24, v20, v20
    v_fmac_f32 v24, v21, v21
    v_rcp_f32 v24, v24
    v_mul_f32 v25, v23, v20
    v_fmac_f32 v25, v15, v21
    v_mul_f32 v17, v15, v20
    v_fma_f32 v17, -v23, v21, v17
    v_mul_f32 v16, v25, v24
    v_mul_f32 v17, v17, v24
    v_mov_b32 v16, v10
    v_mov_b32 v17, v11
    v_mov_b32 v18, v14
    v_mov_b32 v19, v15
    v_mul_f32 v20, v17, v17
    v_mul_f32 v21, v16, v17
    v_fma_f32 v16, v16, v16, -v20
    v_add_f32 v17, v21, v21
    v_mul_f32 v20, v19, v19
    v_mul_f32 v21, v18, v19
    v_fma_f32 v18, v18, v18, -v20
    v_add_f32 v19, v21, v21
    v_mul_f32 v20, v17, v17
    v_mul_f32 v21, v16, v17
    v_fma_f32 v16, v16, v16, -v20
    v_add_f32 v17, v21, v21
    v_mul_f32 v20, v19, v19
    v_mul_f32 v21, v18, v19
    v_fma_f32 v18, v18, v18, -v20
    v_add_f32 v19, v21, v21
    v_mul_f32 v20, v17, v17
    v_mul_f32 v21, v16, v17
    v_fma_f32 v16, v16, v16, -v20
    v_add_f32 v17, v21, v21
    v_mul_f32 v20, v19, v19
    v_mul_f32 v21, v18, v19
    v_fma_f32 v18, v18, v18, -v20
    v_add_f32 v19, v21, v21
    v_mul_f32 v20, v17, v17
    v_mul_f32 v21, v16, v17
    v_fma_f32 v16, v16, v16, -v20
    v_add_f32 v17, v21, v21
    v_mul_f32 v20, v19, v19
    v_mul_f32 v21, v18, v19
    v_fma_f32 v18, v18, v18, -v20
    v_add_f32 v19, v21, v21
    v_mul_f32 v20, v17, v17
    v_mul_f32 v21, v16, v17
    v_fma_f32 v16, v16, v16, -v20
    v_add_f32 v17, v21, v21
    v_mul_f32 v20, v19, v19
    v_mul_f32 v21, v18, v19
    v_fma_f32 v18, v18, v18, -v20
    v_add_f32 v19, v21, v21
    v_mov_b32 v24, 0
    v_mov_b32 v25, 0
    v_mov_b32 v26, 0
    v_mov_b32 v27, 0
    v_lshlrev_b32 v3, 2, v1
    v_add_u32 v4, 2560, v3
    s_mov_b32 s42, 0
    s_mov_b32 s43, 0
K2_CARRY:
    s_cmp_ge_u32 s42, s40
    s_cbranch_scc1 K2_APPLY
    buffer_load_dwordx2 v[32:33], v3, s[60:63], s43 offen
    buffer_load_dwordx2 v[34:35], v4, s[60:63], s43 offen
    s_add_u32 s43, s43, 5120
    buffer_load_dwordx2 v[36:37], v3, s[60:63], s43 offen
    buffer_load_dwordx2 v[38:39], v4, s[60:63], s43 offen
    s_add_u32 s43, s43, 5120
    buffer_load_dwordx2 v[40:41], v3, s[60:63], s43 offen
    buffer_load_dwordx2 v[42:43], v4, s[60:63], s43 offen
    s_add_u32 s43, s43, 5120
    buffer_load_dwordx2 v[44:45], v3, s[60:63], s43 offen
    buffer_load_dwordx2 v[46:47], v4, s[60:63], s43 offen
    s_add_u32 s43, s43, 5120
    buffer_load_dwordx2 v[48:49], v3, s[60:63], s43 offen
    buffer_load_dwordx2 v[50:51], v4, s[60:63], s43 offen
    s_add_u32 s43, s43, 5120
    buffer_load_dwordx2 v[52:53], v3, s[60:63], s43 offen
    buffer_load_dwordx2 v[54:55], v4, s[60:63], s43 offen
    s_add_u32 s43, s43, 5120
    buffer_load_dwordx2 v[56:57], v3, s[60:63], s43 offen
    buffer_load_dwordx2 v[58:59], v4, s[60:63], s43 offen
    s_add_u32 s43, s43, 5120
    buffer_load_dwordx2 v[60:61], v3, s[60:63], s43 offen
    buffer_load_dwordx2 v[62:63], v4, s[60:63], s43 offen
    s_add_u32 s43, s43, 5120
    s_waitcnt vmcnt(14)
    v_fma_f32 v20, v16, v24, v32
    v_fma_f32 v21, v16, v26, v34
    v_fma_f32 v20, -v17, v26, v20
    v_fma_f32 v26, v17, v24, v21
    v_mov_b32 v24, v20
    v_fma_f32 v20, v18, v25, v33
    v_fma_f32 v21, v18, v27, v35
    v_fma_f32 v20, -v19, v27, v20
    v_fma_f32 v27, v19, v25, v21
    v_mov_b32 v25, v20
    s_add_u32 s42, s42, 1
    s_cmp_ge_u32 s42, s40
    s_cbranch_scc1 K2_APPLY
    s_waitcnt vmcnt(12)
    v_fma_f32 v20, v16, v24, v36
    v_fma_f32 v21, v16, v26, v38
    v_fma_f32 v20, -v17, v26, v20
    v_fma_f32 v26, v17, v24, v21
    v_mov_b32 v24, v20
    v_fma_f32 v20, v18, v25, v37
    v_fma_f32 v21, v18, v27, v39
    v_fma_f32 v20, -v19, v27, v20
    v_fma_f32 v27, v19, v25, v21
    v_mov_b32 v25, v20
    s_add_u32 s42, s42, 1
    s_cmp_ge_u32 s42, s40
    s_cbranch_scc1 K2_APPLY
    s_waitcnt vmcnt(10)
    v_fma_f32 v20, v16, v24, v40
    v_fma_f32 v21, v16, v26, v42
    v_fma_f32 v20, -v17, v26, v20
    v_fma_f32 v26, v17, v24, v21
    v_mov_b32 v24, v20
    v_fma_f32 v20, v18, v25, v41
    v_fma_f32 v21, v18, v27, v43
    v_fma_f32 v20, -v19, v27, v20
    v_fma_f32 v27, v19, v25, v21
    v_mov_b32 v25, v20
    s_add_u32 s42, s42, 1
    s_cmp_ge_u32 s42, s40
    s_cbranch_scc1 K2_APPLY
    s_waitcnt vmcnt(8)
    v_fma_f32 v20, v16, v24, v44
    v_fma_f32 v21, v16, v26, v46
    v_fma_f32 v20, -v17, v26, v20
    v_fma_f32 v26, v17, v24, v21
    v_mov_b32 v24, v20
    v_fma_f32 v20, v18, v25, v45
    v_fma_f32 v21, v18, v27, v47
    v_fma_f32 v20, -v19, v27, v20
    v_fma_f32 v27, v19, v25, v21
    v_mov_b32 v25, v20
    s_add_u32 s42, s42, 1
    s_cmp_ge_u32 s42, s40
    s_cbranch_scc1 K2_APPLY
    s_waitcnt vmcnt(6)
    v_fma_f32 v20, v16, v24, v48
    v_fma_f32 v21, v16, v26, v50
    v_fma_f32 v20, -v17, v26, v20
    v_fma_f32 v26, v17, v24, v21
    v_mov_b32 v24, v20
    v_fma_f32 v20, v18, v25, v49
    v_fma_f32 v21, v18, v27, v51
    v_fma_f32 v20, -v19, v27, v20
    v_fma_f32 v27, v19, v25, v21
    v_mov_b32 v25, v20
    s_add_u32 s42, s42, 1
    s_cmp_ge_u32 s42, s40
    s_cbranch_scc1 K2_APPLY
    s_waitcnt vmcnt(4)
    v_fma_f32 v20, v16, v24, v52
    v_fma_f32 v21, v16, v26, v54
    v_fma_f32 v20, -v17, v26, v20
    v_fma_f32 v26, v17, v24, v21
    v_mov_b32 v24, v20
    v_fma_f32 v20, v18, v25, v53
    v_fma_f32 v21, v18, v27, v55
    v_fma_f32 v20, -v19, v27, v20
    v_fma_f32 v27, v19, v25, v21
    v_mov_b32 v25, v20
    s_add_u32 s42, s42, 1
    s_cmp_ge_u32 s42, s40
    s_cbranch_scc1 K2_APPLY
    s_waitcnt vmcnt(2)
    v_fma_f32 v20, v16, v24, v56
    v_fma_f32 v21, v16, v26, v58
    v_fma_f32 v20, -v17, v26, v20
    v_fma_f32 v26, v17, v24, v21
    v_mov_b32 v24, v20
    v_fma_f32 v20, v18, v25, v57
    v_fma_f32 v21, v18, v27, v59
    v_fma_f32 v20, -v19, v27, v20
    v_fma_f32 v27, v19, v25, v21
    v_mov_b32 v25, v20
    s_add_u32 s42, s42, 1
    s_cmp_ge_u32 s42, s40
    s_cbranch_scc1 K2_APPLY
    s_waitcnt vmcnt(0)
    v_fma_f32 v20, v16, v24, v60
    v_fma_f32 v21, v16, v26, v62
    v_fma_f32 v20, -v17, v26, v20
    v_fma_f32 v26, v17, v24, v21
    v_mov_b32 v24, v20
    v_fma_f32 v20, v18, v25, v61
    v_fma_f32 v21, v18, v27, v63
    v_fma_f32 v20, -v19, v27, v20
    v_fma_f32 v27, v19, v25, v21
    v_mov_b32 v25, v20
    s_add_u32 s42, s42, 1
    s_branch K2_CARRY
K2_APPLY:
    s_waitcnt vmcnt(0)
    s_mul_i32 s43, s40, 163840
    s_mul_i32 s44, s40, 81920
    v_lshlrev_b32 v5, 1, v1
    v_add_u32 v6, 1280, v5
    buffer_load_dwordx2 v[32:33], v3, s[56:59], s43 offen
    buffer_load_dwordx2 v[34:35], v4, s[56:59], s43 offen
    s_add_u32 s43, s43, 5120
    buffer_load_dwordx2 v[36:37], v3, s[56:59], s43 offen
    buffer_load_dwordx2 v[38:39], v4, s[56:59], s43 offen
    s_add_u32 s43, s43, 5120
    buffer_load_dwordx2 v[40:41], v3, s[56:59], s43 offen
    buffer_load_dwordx2 v[42:43], v4, s[56:59], s43 offen
    s_add_u32 s43, s43, 5120
    buffer_load_dwordx2 v[44:45], v3, s[56:59], s43 offen
    buffer_load_dwordx2 v[46:47], v4, s[56:59], s43 offen
    s_add_u32 s43, s43, 5120
    buffer_load_dwordx2 v[48:49], v3, s[56:59], s43 offen
    buffer_load_dwordx2 v[50:51], v4, s[56:59], s43 offen
    s_add_u32 s43, s43, 5120
    buffer_load_dwordx2 v[52:53], v3, s[56:59], s43 offen
    buffer_load_dwordx2 v[54:55], v4, s[56:59], s43 offen
    s_add_u32 s43, s43, 5120
    buffer_load_dwordx2 v[56:57], v3, s[56:59], s43 offen
    buffer_load_dwordx2 v[58:59], v4, s[56:59], s43 offen
    s_add_u32 s43, s43, 5120
    buffer_load_dwordx2 v[60:61], v3, s[56:59], s43 offen
    buffer_load_dwordx2 v[62:63], v4, s[56:59], s43 offen
    s_add_u32 s43, s43, 5120
    buffer_load_dwordx2 v[64:65], v3, s[56:59], s43 offen
    buffer_load_dwordx2 v[66:67], v4, s[56:59], s43 offen
    s_add_u32 s43, s43, 5120
    buffer_load_dwordx2 v[68:69], v3, s[56:59], s43 offen
    buffer_load_dwordx2 v[70:71], v4, s[56:59], s43 offen
    s_add_u32 s43, s43, 5120
    buffer_load_dwordx2 v[72:73], v3, s[56:59], s43 offen
    buffer_load_dwordx2 v[74:75], v4, s[56:59], s43 offen
    s_add_u32 s43, s43, 5120
    buffer_load_dwordx2 v[76:77], v3, s[56:59], s43 offen
    buffer_load_dwordx2 v[78:79], v4, s[56:59], s43 offen
    s_add_u32 s43, s43, 5120
    buffer_load_dwordx2 v[80:81], v3, s[56:59], s43 offen
    buffer_load_dwordx2 v[82:83], v4, s[56:59], s43 offen
    s_add_u32 s43, s43, 5120
    buffer_load_dwordx2 v[84:85], v3, s[56:59], s43 offen
    buffer_load_dwordx2 v[86:87], v4, s[56:59], s43 offen
    s_add_u32 s43, s43, 5120
    buffer_load_dwordx2 v[88:89], v3, s[56:59], s43 offen
    buffer_load_dwordx2 v[90:91], v4, s[56:59], s43 offen
    s_add_u32 s43, s43, 5120
    buffer_load_dwordx2 v[92:93], v3, s[56:59], s43 offen
    buffer_load_dwordx2 v[94:95], v4, s[56:59], s43 offen
    s_add_u32 s43, s43, 5120
    s_waitcnt vmcnt(30)
    v_mul_f32 v20, v11, v26
    v_mul_f32 v21, v11, v24
    v_fma_f32 v24, v10, v24, -v20
    v_fma_f32 v26, v10, v26, v21
    v_mul_f32 v20, v15, v27
    v_mul_f32 v21, v15, v25
    v_fma_f32 v25, v14, v25, -v20
    v_fma_f32 v27, v14, v27, v21
    v_add_f32 v32, v32, v24
    v_add_f32 v33, v33, v25
    v_add_f32 v34, v34, v26
    v_add_f32 v35, v35, v27
    v_cvt_pk_bf16_f32 v32, v32, v33
    v_cvt_pk_bf16_f32 v33, -v34, -v35
    buffer_store_dword v32, v5, s[64:67], s44 offen
    buffer_store_dword v33, v6, s[64:67], s44 offen
    s_add_u32 s44, s44, 2560
    s_waitcnt vmcnt(28)
    v_mul_f32 v20, v11, v26
    v_mul_f32 v21, v11, v24
    v_fma_f32 v24, v10, v24, -v20
    v_fma_f32 v26, v10, v26, v21
    v_mul_f32 v20, v15, v27
    v_mul_f32 v21, v15, v25
    v_fma_f32 v25, v14, v25, -v20
    v_fma_f32 v27, v14, v27, v21
    v_add_f32 v36, v36, v24
    v_add_f32 v37, v37, v25
    v_add_f32 v38, v38, v26
    v_add_f32 v39, v39, v27
    v_cvt_pk_bf16_f32 v36, v36, v37
    v_cvt_pk_bf16_f32 v37, -v38, -v39
    buffer_store_dword v36, v5, s[64:67], s44 offen
    buffer_store_dword v37, v6, s[64:67], s44 offen
    s_add_u32 s44, s44, 2560
    s_waitcnt vmcnt(26)
    v_mul_f32 v20, v11, v26
    v_mul_f32 v21, v11, v24
    v_fma_f32 v24, v10, v24, -v20
    v_fma_f32 v26, v10, v26, v21
    v_mul_f32 v20, v15, v27
    v_mul_f32 v21, v15, v25
    v_fma_f32 v25, v14, v25, -v20
    v_fma_f32 v27, v14, v27, v21
    v_add_f32 v40, v40, v24
    v_add_f32 v41, v41, v25
    v_add_f32 v42, v42, v26
    v_add_f32 v43, v43, v27
    v_cvt_pk_bf16_f32 v40, v40, v41
    v_cvt_pk_bf16_f32 v41, -v42, -v43
    buffer_store_dword v40, v5, s[64:67], s44 offen
    buffer_store_dword v41, v6, s[64:67], s44 offen
    s_add_u32 s44, s44, 2560
    s_waitcnt vmcnt(24)
    v_mul_f32 v20, v11, v26
    v_mul_f32 v21, v11, v24
    v_fma_f32 v24, v10, v24, -v20
    v_fma_f32 v26, v10, v26, v21
    v_mul_f32 v20, v15, v27
    v_mul_f32 v21, v15, v25
    v_fma_f32 v25, v14, v25, -v20
    v_fma_f32 v27, v14, v27, v21
    v_add_f32 v44, v44, v24
    v_add_f32 v45, v45, v25
    v_add_f32 v46, v46, v26
    v_add_f32 v47, v47, v27
    v_cvt_pk_bf16_f32 v44, v44, v45
    v_cvt_pk_bf16_f32 v45, -v46, -v47
    buffer_store_dword v44, v5, s[64:67], s44 offen
    buffer_store_dword v45, v6, s[64:67], s44 offen
    s_add_u32 s44, s44, 2560
    s_waitcnt vmcnt(22)
    v_mul_f32 v20, v11, v26
    v_mul_f32 v21, v11, v24
    v_fma_f32 v24, v10, v24, -v20
    v_fma_f32 v26, v10, v26, v21
    v_mul_f32 v20, v15, v27
    v_mul_f32 v21, v15, v25
    v_fma_f32 v25, v14, v25, -v20
    v_fma_f32 v27, v14, v27, v21
    v_add_f32 v48, v48, v24
    v_add_f32 v49, v49, v25
    v_add_f32 v50, v50, v26
    v_add_f32 v51, v51, v27
    v_cvt_pk_bf16_f32 v48, v48, v49
    v_cvt_pk_bf16_f32 v49, -v50, -v51
    buffer_store_dword v48, v5, s[64:67], s44 offen
    buffer_store_dword v49, v6, s[64:67], s44 offen
    s_add_u32 s44, s44, 2560
    s_waitcnt vmcnt(20)
    v_mul_f32 v20, v11, v26
    v_mul_f32 v21, v11, v24
    v_fma_f32 v24, v10, v24, -v20
    v_fma_f32 v26, v10, v26, v21
    v_mul_f32 v20, v15, v27
    v_mul_f32 v21, v15, v25
    v_fma_f32 v25, v14, v25, -v20
    v_fma_f32 v27, v14, v27, v21
    v_add_f32 v52, v52, v24
    v_add_f32 v53, v53, v25
    v_add_f32 v54, v54, v26
    v_add_f32 v55, v55, v27
    v_cvt_pk_bf16_f32 v52, v52, v53
    v_cvt_pk_bf16_f32 v53, -v54, -v55
    buffer_store_dword v52, v5, s[64:67], s44 offen
    buffer_store_dword v53, v6, s[64:67], s44 offen
    s_add_u32 s44, s44, 2560
    s_waitcnt vmcnt(18)
    v_mul_f32 v20, v11, v26
    v_mul_f32 v21, v11, v24
    v_fma_f32 v24, v10, v24, -v20
    v_fma_f32 v26, v10, v26, v21
    v_mul_f32 v20, v15, v27
    v_mul_f32 v21, v15, v25
    v_fma_f32 v25, v14, v25, -v20
    v_fma_f32 v27, v14, v27, v21
    v_add_f32 v56, v56, v24
    v_add_f32 v57, v57, v25
    v_add_f32 v58, v58, v26
    v_add_f32 v59, v59, v27
    v_cvt_pk_bf16_f32 v56, v56, v57
    v_cvt_pk_bf16_f32 v57, -v58, -v59
    buffer_store_dword v56, v5, s[64:67], s44 offen
    buffer_store_dword v57, v6, s[64:67], s44 offen
    s_add_u32 s44, s44, 2560
    s_waitcnt vmcnt(16)
    v_mul_f32 v20, v11, v26
    v_mul_f32 v21, v11, v24
    v_fma_f32 v24, v10, v24, -v20
    v_fma_f32 v26, v10, v26, v21
    v_mul_f32 v20, v15, v27
    v_mul_f32 v21, v15, v25
    v_fma_f32 v25, v14, v25, -v20
    v_fma_f32 v27, v14, v27, v21
    v_add_f32 v60, v60, v24
    v_add_f32 v61, v61, v25
    v_add_f32 v62, v62, v26
    v_add_f32 v63, v63, v27
    v_cvt_pk_bf16_f32 v60, v60, v61
    v_cvt_pk_bf16_f32 v61, -v62, -v63
    buffer_store_dword v60, v5, s[64:67], s44 offen
    buffer_store_dword v61, v6, s[64:67], s44 offen
    s_add_u32 s44, s44, 2560
    s_waitcnt vmcnt(14)
    v_mul_f32 v20, v11, v26
    v_mul_f32 v21, v11, v24
    v_fma_f32 v24, v10, v24, -v20
    v_fma_f32 v26, v10, v26, v21
    v_mul_f32 v20, v15, v27
    v_mul_f32 v21, v15, v25
    v_fma_f32 v25, v14, v25, -v20
    v_fma_f32 v27, v14, v27, v21
    v_add_f32 v64, v64, v24
    v_add_f32 v65, v65, v25
    v_add_f32 v66, v66, v26
    v_add_f32 v67, v67, v27
    v_cvt_pk_bf16_f32 v64, v64, v65
    v_cvt_pk_bf16_f32 v65, -v66, -v67
    buffer_store_dword v64, v5, s[64:67], s44 offen
    buffer_store_dword v65, v6, s[64:67], s44 offen
    s_add_u32 s44, s44, 2560
    s_waitcnt vmcnt(12)
    v_mul_f32 v20, v11, v26
    v_mul_f32 v21, v11, v24
    v_fma_f32 v24, v10, v24, -v20
    v_fma_f32 v26, v10, v26, v21
    v_mul_f32 v20, v15, v27
    v_mul_f32 v21, v15, v25
    v_fma_f32 v25, v14, v25, -v20
    v_fma_f32 v27, v14, v27, v21
    v_add_f32 v68, v68, v24
    v_add_f32 v69, v69, v25
    v_add_f32 v70, v70, v26
    v_add_f32 v71, v71, v27
    v_cvt_pk_bf16_f32 v68, v68, v69
    v_cvt_pk_bf16_f32 v69, -v70, -v71
    buffer_store_dword v68, v5, s[64:67], s44 offen
    buffer_store_dword v69, v6, s[64:67], s44 offen
    s_add_u32 s44, s44, 2560
    s_waitcnt vmcnt(10)
    v_mul_f32 v20, v11, v26
    v_mul_f32 v21, v11, v24
    v_fma_f32 v24, v10, v24, -v20
    v_fma_f32 v26, v10, v26, v21
    v_mul_f32 v20, v15, v27
    v_mul_f32 v21, v15, v25
    v_fma_f32 v25, v14, v25, -v20
    v_fma_f32 v27, v14, v27, v21
    v_add_f32 v72, v72, v24
    v_add_f32 v73, v73, v25
    v_add_f32 v74, v74, v26
    v_add_f32 v75, v75, v27
    v_cvt_pk_bf16_f32 v72, v72, v73
    v_cvt_pk_bf16_f32 v73, -v74, -v75
    buffer_store_dword v72, v5, s[64:67], s44 offen
    buffer_store_dword v73, v6, s[64:67], s44 offen
    s_add_u32 s44, s44, 2560
    s_waitcnt vmcnt(8)
    v_mul_f32 v20, v11, v26
    v_mul_f32 v21, v11, v24
    v_fma_f32 v24, v10, v24, -v20
    v_fma_f32 v26, v10, v26, v21
    v_mul_f32 v20, v15, v27
    v_mul_f32 v21, v15, v25
    v_fma_f32 v25, v14, v25, -v20
    v_fma_f32 v27, v14, v27, v21
    v_add_f32 v76, v76, v24
    v_add_f32 v77, v77, v25
    v_add_f32 v78, v78, v26
    v_add_f32 v79, v79, v27
    v_cvt_pk_bf16_f32 v76, v76, v77
    v_cvt_pk_bf16_f32 v77, -v78, -v79
    buffer_store_dword v76, v5, s[64:67], s44 offen
    buffer_store_dword v77, v6, s[64:67], s44 offen
    s_add_u32 s44, s44, 2560
    s_waitcnt vmcnt(6)
    v_mul_f32 v20, v11, v26
    v_mul_f32 v21, v11, v24
    v_fma_f32 v24, v10, v24, -v20
    v_fma_f32 v26, v10, v26, v21
    v_mul_f32 v20, v15, v27
    v_mul_f32 v21, v15, v25
    v_fma_f32 v25, v14, v25, -v20
    v_fma_f32 v27, v14, v27, v21
    v_add_f32 v80, v80, v24
    v_add_f32 v81, v81, v25
    v_add_f32 v82, v82, v26
    v_add_f32 v83, v83, v27
    v_cvt_pk_bf16_f32 v80, v80, v81
    v_cvt_pk_bf16_f32 v81, -v82, -v83
    buffer_store_dword v80, v5, s[64:67], s44 offen
    buffer_store_dword v81, v6, s[64:67], s44 offen
    s_add_u32 s44, s44, 2560
    s_waitcnt vmcnt(4)
    v_mul_f32 v20, v11, v26
    v_mul_f32 v21, v11, v24
    v_fma_f32 v24, v10, v24, -v20
    v_fma_f32 v26, v10, v26, v21
    v_mul_f32 v20, v15, v27
    v_mul_f32 v21, v15, v25
    v_fma_f32 v25, v14, v25, -v20
    v_fma_f32 v27, v14, v27, v21
    v_add_f32 v84, v84, v24
    v_add_f32 v85, v85, v25
    v_add_f32 v86, v86, v26
    v_add_f32 v87, v87, v27
    v_cvt_pk_bf16_f32 v84, v84, v85
    v_cvt_pk_bf16_f32 v85, -v86, -v87
    buffer_store_dword v84, v5, s[64:67], s44 offen
    buffer_store_dword v85, v6, s[64:67], s44 offen
    s_add_u32 s44, s44, 2560
    s_waitcnt vmcnt(2)
    v_mul_f32 v20, v11, v26
    v_mul_f32 v21, v11, v24
    v_fma_f32 v24, v10, v24, -v20
    v_fma_f32 v26, v10, v26, v21
    v_mul_f32 v20, v15, v27
    v_mul_f32 v21, v15, v25
    v_fma_f32 v25, v14, v25, -v20
    v_fma_f32 v27, v14, v27, v21
    v_add_f32 v88, v88, v24
    v_add_f32 v89, v89, v25
    v_add_f32 v90, v90, v26
    v_add_f32 v91, v91, v27
    v_cvt_pk_bf16_f32 v88, v88, v89
    v_cvt_pk_bf16_f32 v89, -v90, -v91
    buffer_store_dword v88, v5, s[64:67], s44 offen
    buffer_store_dword v89, v6, s[64:67], s44 offen
    s_add_u32 s44, s44, 2560
    s_waitcnt vmcnt(0)
    v_mul_f32 v20, v11, v26
    v_mul_f32 v21, v11, v24
    v_fma_f32 v24, v10, v24, -v20
    v_fma_f32 v26, v10, v26, v21
    v_mul_f32 v20, v15, v27
    v_mul_f32 v21, v15, v25
    v_fma_f32 v25, v14, v25, -v20
    v_fma_f32 v27, v14, v27, v21
    v_add_f32 v92, v92, v24
    v_add_f32 v93, v93, v25
    v_add_f32 v94, v94, v26
    v_add_f32 v95, v95, v27
    v_cvt_pk_bf16_f32 v92, v92, v93
    v_cvt_pk_bf16_f32 v93, -v94, -v95
    buffer_store_dword v92, v5, s[64:67], s44 offen
    buffer_store_dword v93, v6, s[64:67], s44 offen
    s_add_u32 s44, s44, 2560
    buffer_load_dwordx2 v[32:33], v3, s[56:59], s43 offen
    buffer_load_dwordx2 v[34:35], v4, s[56:59], s43 offen
    s_add_u32 s43, s43, 5120
    buffer_load_dwordx2 v[36:37], v3, s[56:59], s43 offen
    buffer_load_dwordx2 v[38:39], v4, s[56:59], s43 offen
    s_add_u32 s43, s43, 5120
    buffer_load_dwordx2 v[40:41], v3, s[56:59], s43 offen
    buffer_load_dwordx2 v[42:43], v4, s[56:59], s43 offen
    s_add_u32 s43, s43, 5120
    buffer_load_dwordx2 v[44:45], v3, s[56:59], s43 offen
    buffer_load_dwordx2 v[46:47], v4, s[56:59], s43 offen
    s_add_u32 s43, s43, 5120
    buffer_load_dwordx2 v[48:49], v3, s[56:59], s43 offen
    buffer_load_dwordx2 v[50:51], v4, s[56:59], s43 offen
    s_add_u32 s43, s43, 5120
    buffer_load_dwordx2 v[52:53], v3, s[56:59], s43 offen
    buffer_load_dwordx2 v[54:55], v4, s[56:59], s43 offen
    s_add_u32 s43, s43, 5120
    buffer_load_dwordx2 v[56:57], v3, s[56:59], s43 offen
    buffer_load_dwordx2 v[58:59], v4, s[56:59], s43 offen
    s_add_u32 s43, s43, 5120
    buffer_load_dwordx2 v[60:61], v3, s[56:59], s43 offen
    buffer_load_dwordx2 v[62:63], v4, s[56:59], s43 offen
    s_add_u32 s43, s43, 5120
    buffer_load_dwordx2 v[64:65], v3, s[56:59], s43 offen
    buffer_load_dwordx2 v[66:67], v4, s[56:59], s43 offen
    s_add_u32 s43, s43, 5120
    buffer_load_dwordx2 v[68:69], v3, s[56:59], s43 offen
    buffer_load_dwordx2 v[70:71], v4, s[56:59], s43 offen
    s_add_u32 s43, s43, 5120
    buffer_load_dwordx2 v[72:73], v3, s[56:59], s43 offen
    buffer_load_dwordx2 v[74:75], v4, s[56:59], s43 offen
    s_add_u32 s43, s43, 5120
    buffer_load_dwordx2 v[76:77], v3, s[56:59], s43 offen
    buffer_load_dwordx2 v[78:79], v4, s[56:59], s43 offen
    s_add_u32 s43, s43, 5120
    buffer_load_dwordx2 v[80:81], v3, s[56:59], s43 offen
    buffer_load_dwordx2 v[82:83], v4, s[56:59], s43 offen
    s_add_u32 s43, s43, 5120
    buffer_load_dwordx2 v[84:85], v3, s[56:59], s43 offen
    buffer_load_dwordx2 v[86:87], v4, s[56:59], s43 offen
    s_add_u32 s43, s43, 5120
    buffer_load_dwordx2 v[88:89], v3, s[56:59], s43 offen
    buffer_load_dwordx2 v[90:91], v4, s[56:59], s43 offen
    s_add_u32 s43, s43, 5120
    buffer_load_dwordx2 v[92:93], v3, s[56:59], s43 offen
    buffer_load_dwordx2 v[94:95], v4, s[56:59], s43 offen
    s_add_u32 s43, s43, 5120
    s_waitcnt vmcnt(30)
    v_mul_f32 v20, v11, v26
    v_mul_f32 v21, v11, v24
    v_fma_f32 v24, v10, v24, -v20
    v_fma_f32 v26, v10, v26, v21
    v_mul_f32 v20, v15, v27
    v_mul_f32 v21, v15, v25
    v_fma_f32 v25, v14, v25, -v20
    v_fma_f32 v27, v14, v27, v21
    v_add_f32 v32, v32, v24
    v_add_f32 v33, v33, v25
    v_add_f32 v34, v34, v26
    v_add_f32 v35, v35, v27
    v_cvt_pk_bf16_f32 v32, v32, v33
    v_cvt_pk_bf16_f32 v33, -v34, -v35
    buffer_store_dword v32, v5, s[64:67], s44 offen
    buffer_store_dword v33, v6, s[64:67], s44 offen
    s_add_u32 s44, s44, 2560
    s_waitcnt vmcnt(28)
    v_mul_f32 v20, v11, v26
    v_mul_f32 v21, v11, v24
    v_fma_f32 v24, v10, v24, -v20
    v_fma_f32 v26, v10, v26, v21
    v_mul_f32 v20, v15, v27
    v_mul_f32 v21, v15, v25
    v_fma_f32 v25, v14, v25, -v20
    v_fma_f32 v27, v14, v27, v21
    v_add_f32 v36, v36, v24
    v_add_f32 v37, v37, v25
    v_add_f32 v38, v38, v26
    v_add_f32 v39, v39, v27
    v_cvt_pk_bf16_f32 v36, v36, v37
    v_cvt_pk_bf16_f32 v37, -v38, -v39
    buffer_store_dword v36, v5, s[64:67], s44 offen
    buffer_store_dword v37, v6, s[64:67], s44 offen
    s_add_u32 s44, s44, 2560
    s_waitcnt vmcnt(26)
    v_mul_f32 v20, v11, v26
    v_mul_f32 v21, v11, v24
    v_fma_f32 v24, v10, v24, -v20
    v_fma_f32 v26, v10, v26, v21
    v_mul_f32 v20, v15, v27
    v_mul_f32 v21, v15, v25
    v_fma_f32 v25, v14, v25, -v20
    v_fma_f32 v27, v14, v27, v21
    v_add_f32 v40, v40, v24
    v_add_f32 v41, v41, v25
    v_add_f32 v42, v42, v26
    v_add_f32 v43, v43, v27
    v_cvt_pk_bf16_f32 v40, v40, v41
    v_cvt_pk_bf16_f32 v41, -v42, -v43
    buffer_store_dword v40, v5, s[64:67], s44 offen
    buffer_store_dword v41, v6, s[64:67], s44 offen
    s_add_u32 s44, s44, 2560
    s_waitcnt vmcnt(24)
    v_mul_f32 v20, v11, v26
    v_mul_f32 v21, v11, v24
    v_fma_f32 v24, v10, v24, -v20
    v_fma_f32 v26, v10, v26, v21
    v_mul_f32 v20, v15, v27
    v_mul_f32 v21, v15, v25
    v_fma_f32 v25, v14, v25, -v20
    v_fma_f32 v27, v14, v27, v21
    v_add_f32 v44, v44, v24
    v_add_f32 v45, v45, v25
    v_add_f32 v46, v46, v26
    v_add_f32 v47, v47, v27
    v_cvt_pk_bf16_f32 v44, v44, v45
    v_cvt_pk_bf16_f32 v45, -v46, -v47
    buffer_store_dword v44, v5, s[64:67], s44 offen
    buffer_store_dword v45, v6, s[64:67], s44 offen
    s_add_u32 s44, s44, 2560
    s_waitcnt vmcnt(22)
    v_mul_f32 v20, v11, v26
    v_mul_f32 v21, v11, v24
    v_fma_f32 v24, v10, v24, -v20
    v_fma_f32 v26, v10, v26, v21
    v_mul_f32 v20, v15, v27
    v_mul_f32 v21, v15, v25
    v_fma_f32 v25, v14, v25, -v20
    v_fma_f32 v27, v14, v27, v21
    v_add_f32 v48, v48, v24
    v_add_f32 v49, v49, v25
    v_add_f32 v50, v50, v26
    v_add_f32 v51, v51, v27
    v_cvt_pk_bf16_f32 v48, v48, v49
    v_cvt_pk_bf16_f32 v49, -v50, -v51
    buffer_store_dword v48, v5, s[64:67], s44 offen
    buffer_store_dword v49, v6, s[64:67], s44 offen
    s_add_u32 s44, s44, 2560
    s_waitcnt vmcnt(20)
    v_mul_f32 v20, v11, v26
    v_mul_f32 v21, v11, v24
    v_fma_f32 v24, v10, v24, -v20
    v_fma_f32 v26, v10, v26, v21
    v_mul_f32 v20, v15, v27
    v_mul_f32 v21, v15, v25
    v_fma_f32 v25, v14, v25, -v20
    v_fma_f32 v27, v14, v27, v21
    v_add_f32 v52, v52, v24
    v_add_f32 v53, v53, v25
    v_add_f32 v54, v54, v26
    v_add_f32 v55, v55, v27
    v_cvt_pk_bf16_f32 v52, v52, v53
    v_cvt_pk_bf16_f32 v53, -v54, -v55
    buffer_store_dword v52, v5, s[64:67], s44 offen
    buffer_store_dword v53, v6, s[64:67], s44 offen
    s_add_u32 s44, s44, 2560
    s_waitcnt vmcnt(18)
    v_mul_f32 v20, v11, v26
    v_mul_f32 v21, v11, v24
    v_fma_f32 v24, v10, v24, -v20
    v_fma_f32 v26, v10, v26, v21
    v_mul_f32 v20, v15, v27
    v_mul_f32 v21, v15, v25
    v_fma_f32 v25, v14, v25, -v20
    v_fma_f32 v27, v14, v27, v21
    v_add_f32 v56, v56, v24
    v_add_f32 v57, v57, v25
    v_add_f32 v58, v58, v26
    v_add_f32 v59, v59, v27
    v_cvt_pk_bf16_f32 v56, v56, v57
    v_cvt_pk_bf16_f32 v57, -v58, -v59
    buffer_store_dword v56, v5, s[64:67], s44 offen
    buffer_store_dword v57, v6, s[64:67], s44 offen
    s_add_u32 s44, s44, 2560
    s_waitcnt vmcnt(16)
    v_mul_f32 v20, v11, v26
    v_mul_f32 v21, v11, v24
    v_fma_f32 v24, v10, v24, -v20
    v_fma_f32 v26, v10, v26, v21
    v_mul_f32 v20, v15, v27
    v_mul_f32 v21, v15, v25
    v_fma_f32 v25, v14, v25, -v20
    v_fma_f32 v27, v14, v27, v21
    v_add_f32 v60, v60, v24
    v_add_f32 v61, v61, v25
    v_add_f32 v62, v62, v26
    v_add_f32 v63, v63, v27
    v_cvt_pk_bf16_f32 v60, v60, v61
    v_cvt_pk_bf16_f32 v61, -v62, -v63
    buffer_store_dword v60, v5, s[64:67], s44 offen
    buffer_store_dword v61, v6, s[64:67], s44 offen
    s_add_u32 s44, s44, 2560
    s_waitcnt vmcnt(14)
    v_mul_f32 v20, v11, v26
    v_mul_f32 v21, v11, v24
    v_fma_f32 v24, v10, v24, -v20
    v_fma_f32 v26, v10, v26, v21
    v_mul_f32 v20, v15, v27
    v_mul_f32 v21, v15, v25
    v_fma_f32 v25, v14, v25, -v20
    v_fma_f32 v27, v14, v27, v21
    v_add_f32 v64, v64, v24
    v_add_f32 v65, v65, v25
    v_add_f32 v66, v66, v26
    v_add_f32 v67, v67, v27
    v_cvt_pk_bf16_f32 v64, v64, v65
    v_cvt_pk_bf16_f32 v65, -v66, -v67
    buffer_store_dword v64, v5, s[64:67], s44 offen
    buffer_store_dword v65, v6, s[64:67], s44 offen
    s_add_u32 s44, s44, 2560
    s_waitcnt vmcnt(12)
    v_mul_f32 v20, v11, v26
    v_mul_f32 v21, v11, v24
    v_fma_f32 v24, v10, v24, -v20
    v_fma_f32 v26, v10, v26, v21
    v_mul_f32 v20, v15, v27
    v_mul_f32 v21, v15, v25
    v_fma_f32 v25, v14, v25, -v20
    v_fma_f32 v27, v14, v27, v21
    v_add_f32 v68, v68, v24
    v_add_f32 v69, v69, v25
    v_add_f32 v70, v70, v26
    v_add_f32 v71, v71, v27
    v_cvt_pk_bf16_f32 v68, v68, v69
    v_cvt_pk_bf16_f32 v69, -v70, -v71
    buffer_store_dword v68, v5, s[64:67], s44 offen
    buffer_store_dword v69, v6, s[64:67], s44 offen
    s_add_u32 s44, s44, 2560
    s_waitcnt vmcnt(10)
    v_mul_f32 v20, v11, v26
    v_mul_f32 v21, v11, v24
    v_fma_f32 v24, v10, v24, -v20
    v_fma_f32 v26, v10, v26, v21
    v_mul_f32 v20, v15, v27
    v_mul_f32 v21, v15, v25
    v_fma_f32 v25, v14, v25, -v20
    v_fma_f32 v27, v14, v27, v21
    v_add_f32 v72, v72, v24
    v_add_f32 v73, v73, v25
    v_add_f32 v74, v74, v26
    v_add_f32 v75, v75, v27
    v_cvt_pk_bf16_f32 v72, v72, v73
    v_cvt_pk_bf16_f32 v73, -v74, -v75
    buffer_store_dword v72, v5, s[64:67], s44 offen
    buffer_store_dword v73, v6, s[64:67], s44 offen
    s_add_u32 s44, s44, 2560
    s_waitcnt vmcnt(8)
    v_mul_f32 v20, v11, v26
    v_mul_f32 v21, v11, v24
    v_fma_f32 v24, v10, v24, -v20
    v_fma_f32 v26, v10, v26, v21
    v_mul_f32 v20, v15, v27
    v_mul_f32 v21, v15, v25
    v_fma_f32 v25, v14, v25, -v20
    v_fma_f32 v27, v14, v27, v21
    v_add_f32 v76, v76, v24
    v_add_f32 v77, v77, v25
    v_add_f32 v78, v78, v26
    v_add_f32 v79, v79, v27
    v_cvt_pk_bf16_f32 v76, v76, v77
    v_cvt_pk_bf16_f32 v77, -v78, -v79
    buffer_store_dword v76, v5, s[64:67], s44 offen
    buffer_store_dword v77, v6, s[64:67], s44 offen
    s_add_u32 s44, s44, 2560
    s_waitcnt vmcnt(6)
    v_mul_f32 v20, v11, v26
    v_mul_f32 v21, v11, v24
    v_fma_f32 v24, v10, v24, -v20
    v_fma_f32 v26, v10, v26, v21
    v_mul_f32 v20, v15, v27
    v_mul_f32 v21, v15, v25
    v_fma_f32 v25, v14, v25, -v20
    v_fma_f32 v27, v14, v27, v21
    v_add_f32 v80, v80, v24
    v_add_f32 v81, v81, v25
    v_add_f32 v82, v82, v26
    v_add_f32 v83, v83, v27
    v_cvt_pk_bf16_f32 v80, v80, v81
    v_cvt_pk_bf16_f32 v81, -v82, -v83
    buffer_store_dword v80, v5, s[64:67], s44 offen
    buffer_store_dword v81, v6, s[64:67], s44 offen
    s_add_u32 s44, s44, 2560
    s_waitcnt vmcnt(4)
    v_mul_f32 v20, v11, v26
    v_mul_f32 v21, v11, v24
    v_fma_f32 v24, v10, v24, -v20
    v_fma_f32 v26, v10, v26, v21
    v_mul_f32 v20, v15, v27
    v_mul_f32 v21, v15, v25
    v_fma_f32 v25, v14, v25, -v20
    v_fma_f32 v27, v14, v27, v21
    v_add_f32 v84, v84, v24
    v_add_f32 v85, v85, v25
    v_add_f32 v86, v86, v26
    v_add_f32 v87, v87, v27
    v_cvt_pk_bf16_f32 v84, v84, v85
    v_cvt_pk_bf16_f32 v85, -v86, -v87
    buffer_store_dword v84, v5, s[64:67], s44 offen
    buffer_store_dword v85, v6, s[64:67], s44 offen
    s_add_u32 s44, s44, 2560
    s_waitcnt vmcnt(2)
    v_mul_f32 v20, v11, v26
    v_mul_f32 v21, v11, v24
    v_fma_f32 v24, v10, v24, -v20
    v_fma_f32 v26, v10, v26, v21
    v_mul_f32 v20, v15, v27
    v_mul_f32 v21, v15, v25
    v_fma_f32 v25, v14, v25, -v20
    v_fma_f32 v27, v14, v27, v21
    v_add_f32 v88, v88, v24
    v_add_f32 v89, v89, v25
    v_add_f32 v90, v90, v26
    v_add_f32 v91, v91, v27
    v_cvt_pk_bf16_f32 v88, v88, v89
    v_cvt_pk_bf16_f32 v89, -v90, -v91
    buffer_store_dword v88, v5, s[64:67], s44 offen
    buffer_store_dword v89, v6, s[64:67], s44 offen
    s_add_u32 s44, s44, 2560
    s_waitcnt vmcnt(0)
    v_mul_f32 v20, v11, v26
    v_mul_f32 v21, v11, v24
    v_fma_f32 v24, v10, v24, -v20
    v_fma_f32 v26, v10, v26, v21
    v_mul_f32 v20, v15, v27
    v_mul_f32 v21, v15, v25
    v_fma_f32 v25, v14, v25, -v20
    v_fma_f32 v27, v14, v27, v21
    v_add_f32 v92, v92, v24
    v_add_f32 v93, v93, v25
    v_add_f32 v94, v94, v26
    v_add_f32 v95, v95, v27
    v_cvt_pk_bf16_f32 v92, v92, v93
    v_cvt_pk_bf16_f32 v93, -v94, -v95
    buffer_store_dword v92, v5, s[64:67], s44 offen
    buffer_store_dword v93, v6, s[64:67], s44 offen
    s_add_u32 s44, s44, 2560
    s_branch K2_END
K2_GATE:
    s_mov_b32 s8, s4
    s_mov_b32 s9, s5
    s_mov_b32 s10, 2621440
    s_mov_b32 s11, 0x00020000
    s_mov_b32 s12, s34
    s_mov_b32 s13, s35
    s_mov_b32 s14, 1280
    s_mov_b32 s15, 0x00020000
    s_add_u32 s16, s36, 27262976
    s_addc_u32 s17, s37, 0
    s_mov_b32 s18, 8192
    s_mov_b32 s19, 0x00020000
    s_sub_u32 s40, s2, 320
    s_lshl_b32 s40, s40, 3
    v_lshlrev_b32 v1, 2, v0
    buffer_load_dword v10, v1, s[12:15], 0 offen offset:0
    buffer_load_dword v11, v1, s[12:15], 0 offen offset:256
    buffer_load_dword v12, v1, s[12:15], 0 offen offset:512
    buffer_load_dword v13, v1, s[12:15], 0 offen offset:768
    buffer_load_dword v14, v1, s[12:15], 0 offen offset:1024
    s_mul_i32 s41, s40, 1280
    s_mov_b32 s42, 0
K2_GROW:
    buffer_load_dword v20, v1, s[8:11], s41 offen offset:0
    buffer_load_dword v21, v1, s[8:11], s41 offen offset:256
    buffer_load_dword v22, v1, s[8:11], s41 offen offset:512
    buffer_load_dword v23, v1, s[8:11], s41 offen offset:768
    buffer_load_dword v24, v1, s[8:11], s41 offen offset:1024
    s_waitcnt vmcnt(0)
    v_mov_b32 v30, 0
    v_lshlrev_b32 v31, 16, v10
    v_lshlrev_b32 v32, 16, v20
    v_and_b32 v33, 0xffff0000, v10
    v_and_b32 v34, 0xffff0000, v20
    v_mul_f32 v31, v31, v32
    v_mul_f32 v33, v33, v34
    v_cvt_pk_bf16_f32 v31, v31, v33
    v_lshlrev_b32 v32, 16, v31
    v_and_b32 v33, 0xffff0000, v31
    v_add_f32 v30, v30, v32
    v_add_f32 v30, v30, v33
    v_lshlrev_b32 v31, 16, v11
    v_lshlrev_b32 v32, 16, v21
    v_and_b32 v33, 0xffff0000, v11
    v_and_b32 v34, 0xffff0000, v21
    v_mul_f32 v31, v31, v32
    v_mul_f32 v33, v33, v34
    v_cvt_pk_bf16_f32 v31, v31, v33
    v_lshlrev_b32 v32, 16, v31
    v_and_b32 v33, 0xffff0000, v31
    v_add_f32 v30, v30, v32
    v_add_f32 v30, v30, v33
    v_lshlrev_b32 v31, 16, v12
    v_lshlrev_b32 v32, 16, v22
    v_and_b32 v33, 0xffff0000, v12
    v_and_b32 v34, 0xffff0000, v22
    v_mul_f32 v31, v31, v32
    v_mul_f32 v33, v33, v34
    v_cvt_pk_bf16_f32 v31, v31, v33
    v_lshlrev_b32 v32, 16, v31
    v_and_b32 v33, 0xffff0000, v31
    v_add_f32 v30, v30, v32
    v_add_f32 v30, v30, v33
    v_lshlrev_b32 v31, 16, v13
    v_lshlrev_b32 v32, 16, v23
    v_and_b32 v33, 0xffff0000, v13
    v_and_b32 v34, 0xffff0000, v23
    v_mul_f32 v31, v31, v32
    v_mul_f32 v33, v33, v34
    v_cvt_pk_bf16_f32 v31, v31, v33
    v_lshlrev_b32 v32, 16, v31
    v_and_b32 v33, 0xffff0000, v31
    v_add_f32 v30, v30, v32
    v_add_f32 v30, v30, v33
    v_lshlrev_b32 v31, 16, v14
    v_lshlrev_b32 v32, 16, v24
    v_and_b32 v33, 0xffff0000, v14
    v_and_b32 v34, 0xffff0000, v24
    v_mul_f32 v31, v31, v32
    v_mul_f32 v33, v33, v34
    v_cvt_pk_bf16_f32 v31, v31, v33
    v_lshlrev_b32 v32, 16, v31
    v_and_b32 v33, 0xffff0000, v31
    v_add_f32 v30, v30, v32
    v_add_f32 v30, v30, v33
    ds_swizzle_b32 v31, v30 offset:1055
    s_waitcnt lgkmcnt(0)
    v_add_f32 v30, v30, v31
    ds_swizzle_b32 v31, v30 offset:2079
    s_waitcnt lgkmcnt(0)
    v_add_f32 v30, v30, v31
    ds_swizzle_b32 v31, v30 offset:4127
    s_waitcnt lgkmcnt(0)
    v_add_f32 v30, v30, v31
    ds_swizzle_b32 v31, v30 offset:8223
    s_waitcnt lgkmcnt(0)
    v_add_f32 v30, v30, v31
    ds_swizzle_b32 v31, v30 offset:16415
    s_waitcnt lgkmcnt(0)
    v_add_f32 v30, v30, v31
    s_nop 1
    v_readlane_b32 s44, v30, 32
    v_readlane_b32 s45, v30, 0
    s_nop 3
    v_mov_b32 v31, s44
    v_add_f32 v31, s45, v31
    v_cvt_pk_bf16_f32 v31, v31, v31
    v_lshlrev_b32 v31, 16, v31
    v_mul_f32 v31, 0xbfb8aa3b, v31
    v_exp_f32 v31, v31
    s_nop 0
    v_add_f32 v31, 1.0, v31
    v_rcp_f32 v31, v31
    s_nop 0
    v_cvt_pk_bf16_f32 v31, v31, v31
    v_lshlrev_b32 v31, 16, v31
    s_add_u32 s46, s40, s42
    s_lshl_b32 s46, s46, 2
    v_mov_b32 v32, 0
    v_cmp_eq_u32 vcc, 0, v0
    s_and_saveexec_b64 s[48:49], vcc
    buffer_store_dword v31, v32, s[16:19], s46 offen
    s_mov_b64 exec, s[48:49]
    s_add_u32 s41, s41, 1280
    s_add_u32 s42, s42, 1
    s_cmp_lt_u32 s42, 8
    s_cbranch_scc1 K2_GROW
K2_END:
    s_endpgm
.globl k3_kernel
.p2align 8
.type k3_kernel,@function
k3_kernel:
    s_cmp_ge_u32 s2, 160
    s_cbranch_scc1 K3_END
    s_load_dwordx2 s[4:5], s[0:1], 0
    s_load_dwordx4 s[24:27], s[0:1], 40
    s_load_dwordx2 s[28:29], s[0:1], 64
    s_load_dwordx2 s[30:31], s[0:1], 88
    s_load_dwordx2 s[32:33], s[0:1], 104
    s_load_dwordx2 s[36:37], s[0:1], 120
    v_lshrrev_b32 v1, 3, v0
    v_mul_u32_u24 v1, 144, v1
    v_and_b32 v2, 7, v0
    v_lshl_add_u32 v4, v2, 4, v1
    v_add_u32 v5, 18432, v4
    v_lshrrev_b32 v1, 4, v0
    v_mul_u32_u24 v1, 320, v1
    v_and_b32 v2, 15, v0
    v_lshl_add_u32 v6, v2, 4, v1
    v_add_u32 v6, 18432, v6
    v_and_b32 v1, 31, v0
    v_bfe_u32 v2, v0, 5, 1
    v_lshrrev_b32 v3, 7, v0
    v_mul_u32_u24 v3, 32, v3
    v_add_u32 v3, v3, v1
    v_mul_u32_u24 v3, 144, v3
    v_lshl_add_u32 v7, v2, 4, v3
    v_bfe_u32 v3, v0, 6, 1
    v_mul_u32_u24 v3, 64, v3
    v_add_u32 v3, v3, v1
    v_mul_u32_u24 v3, 144, v3
    v_lshl_add_u32 v3, v2, 4, v3
    v_add_u32 v8, 18432, v3
    v_bfe_u32 v1, v0, 2, 2
    v_lshl_add_u32 v1, v2, 3, v1
    v_mul_u32_u24 v1, 320, v1
    v_bfe_u32 v3, v0, 6, 1
    v_mul_u32_u24 v3, 64, v3
    v_bfe_u32 v2, v0, 4, 1
    v_lshl_add_u32 v3, v2, 4, v3
    v_and_b32 v2, 3, v0
    v_lshl_add_u32 v3, v2, 2, v3
    v_lshl_add_u32 v1, v3, 1, v1
    v_add_u32 v9, 18432, v1
    s_waitcnt lgkmcnt(0)
    s_and_b32 s40, s2, 31
    s_lshl_b32 s41, s40, 6
    s_lshr_b32 s42, s2, 5
    s_lshl_b32 s43, s42, 7
    s_add_u32 s8, s36, 22020096
    s_addc_u32 s9, s37, 0
    s_mov_b32 s10, 5242880
    s_mov_b32 s11, 0x00020000
    s_mov_b32 s12, s24
    s_mov_b32 s13, s25
    s_mov_b32 s14, 819200
    s_mov_b32 s15, 0x00020000
    s_mov_b32 s16, s26
    s_mov_b32 s17, s27
    s_mov_b32 s18, 819200
    s_mov_b32 s19, 0x00020000
    s_mov_b32 s20, s36
    s_mov_b32 s21, s37
    s_mov_b32 s22, 7077888
    s_mov_b32 s23, 0x00020000
    s_mov_b32 s44, s30
    s_mov_b32 s45, s31
    s_mov_b32 s46, 2211840
    s_mov_b32 s47, 0x00020000
    v_lshrrev_b32 v1, 3, v0
    v_add_u32 v1, s41, v1
    v_and_b32 v2, 7, v0
    v_lshlrev_b32 v2, 4, v2
    v_mul_u32_u24 v3, 2560, v1
    v_add_u32 v10, v2, v3
    v_add_u32 v11, 81920, v10
    v_mul_u32_u24 v3, 3456, v1
    v_add_u32 v12, v2, v3
    v_add_u32 v13, 110592, v12
    v_lshrrev_b32 v1, 3, v0
    v_add_u32 v1, s43, v1
    v_mul_u32_u24 v1, 1280, v1
    v_add_u32 v14, v2, v1
    v_add_u32 v15, 40960, v14
    v_add_u32 v16, 81920, v14
    v_add_u32 v17, 122880, v14
    v_lshrrev_b32 v1, 4, v0
    v_mul_u32_u24 v1, 1280, v1
    v_and_b32 v2, 15, v0
    v_lshl_add_u32 v1, v2, 4, v1
    s_lshl_b32 s48, s43, 1
    v_add_u32 v18, s48, v1
    v_add_u32 v19, 20480, v18
    v_add_u32 v20, 40960, v18
    v_add_u32 v21, 61440, v18
    v_mov_b32 v72, 0
    v_mov_b32 v73, 0
    v_mov_b32 v74, 0
    v_mov_b32 v75, 0
    v_mov_b32 v76, 0
    v_mov_b32 v77, 0
    v_mov_b32 v78, 0
    v_mov_b32 v79, 0
    v_mov_b32 v80, 0
    v_mov_b32 v81, 0
    v_mov_b32 v82, 0
    v_mov_b32 v83, 0
    v_mov_b32 v84, 0
    v_mov_b32 v85, 0
    v_mov_b32 v86, 0
    v_mov_b32 v87, 0
    v_mov_b32 v88, 0
    v_mov_b32 v89, 0
    v_mov_b32 v90, 0
    v_mov_b32 v91, 0
    v_mov_b32 v92, 0
    v_mov_b32 v93, 0
    v_mov_b32 v94, 0
    v_mov_b32 v95, 0
    v_mov_b32 v96, 0
    v_mov_b32 v97, 0
    v_mov_b32 v98, 0
    v_mov_b32 v99, 0
    v_mov_b32 v100, 0
    v_mov_b32 v101, 0
    v_mov_b32 v102, 0
    v_mov_b32 v103, 0
    v_mov_b32 v104, 0
    v_mov_b32 v105, 0
    v_mov_b32 v106, 0
    v_mov_b32 v107, 0
    v_mov_b32 v108, 0
    v_mov_b32 v109, 0
    v_mov_b32 v110, 0
    v_mov_b32 v111, 0
    v_mov_b32 v112, 0
    v_mov_b32 v113, 0
    v_mov_b32 v114, 0
    v_mov_b32 v115, 0
    v_mov_b32 v116, 0
    v_mov_b32 v117, 0
    v_mov_b32 v118, 0
    v_mov_b32 v119, 0
    v_mov_b32 v120, 0
    v_mov_b32 v121, 0
    v_mov_b32 v122, 0
    v_mov_b32 v123, 0
    v_mov_b32 v124, 0
    v_mov_b32 v125, 0
    v_mov_b32 v126, 0
    v_mov_b32 v127, 0
    v_mov_b32 v128, 0
    v_mov_b32 v129, 0
    v_mov_b32 v130, 0
    v_mov_b32 v131, 0
    v_mov_b32 v132, 0
    v_mov_b32 v133, 0
    v_mov_b32 v134, 0
    v_mov_b32 v135, 0
    s_mov_b32 s90, 0
    s_mov_b32 s91, 0
    buffer_load_dwordx4 v[24:27], v10, s[8:11], s90 offen
    buffer_load_dwordx4 v[28:31], v11, s[8:11], s90 offen
    buffer_load_dwordx4 v[32:35], v14, s[12:15], s91 offen
    buffer_load_dwordx4 v[36:39], v15, s[12:15], s91 offen
    buffer_load_dwordx4 v[40:43], v16, s[12:15], s91 offen
    buffer_load_dwordx4 v[44:47], v17, s[12:15], s91 offen
    s_mov_b32 s90, 128
    s_mov_b32 s91, 128
    buffer_load_dwordx4 v[136:139], v10, s[8:11], s90 offen
    buffer_load_dwordx4 v[140:143], v11, s[8:11], s90 offen
    buffer_load_dwordx4 v[144:147], v14, s[12:15], s91 offen
    buffer_load_dwordx4 v[148:151], v15, s[12:15], s91 offen
    buffer_load_dwordx4 v[152:155], v16, s[12:15], s91 offen
    buffer_load_dwordx4 v[156:159], v17, s[12:15], s91 offen
    s_waitcnt vmcnt(6)
    ds_write_b128 v4, v[24:27] offset:0
    ds_write_b128 v4, v[28:31] offset:4608
    ds_write_b128 v5, v[32:35] offset:0
    ds_write_b128 v5, v[36:39] offset:4608
    ds_write_b128 v5, v[40:43] offset:9216
    ds_write_b128 v5, v[44:47] offset:13824
    s_waitcnt lgkmcnt(0)
    s_barrier
    s_mov_b32 s90, 256
    s_mov_b32 s91, 256
    buffer_load_dwordx4 v[24:27], v10, s[8:11], s90 offen
    buffer_load_dwordx4 v[28:31], v11, s[8:11], s90 offen
    buffer_load_dwordx4 v[32:35], v14, s[12:15], s91 offen
    buffer_load_dwordx4 v[36:39], v15, s[12:15], s91 offen
    buffer_load_dwordx4 v[40:43], v16, s[12:15], s91 offen
    buffer_load_dwordx4 v[44:47], v17, s[12:15], s91 offen
    ds_read_b128 v[48:51], v7 offset:0
    ds_read_b128 v[56:59], v8 offset:0
    ds_read_b128 v[60:63], v8 offset:4608
    ds_read_b128 v[52:55], v7 offset:32
    ds_read_b128 v[64:67], v8 offset:32
    ds_read_b128 v[68:71], v8 offset:4640
    s_waitcnt lgkmcnt(3)
    v_mfma_f32_32x32x16_bf16 v[72:87], v[56:59], v[48:51], v[72:87]
    v_mfma_f32_32x32x16_bf16 v[88:103], v[60:63], v[48:51], v[88:103]
    ds_read_b128 v[48:51], v7 offset:64
    ds_read_b128 v[56:59], v8 offset:64
    ds_read_b128 v[60:63], v8 offset:4672
    s_waitcnt lgkmcnt(3)
    v_mfma_f32_32x32x16_bf16 v[72:87], v[64:67], v[52:55], v[72:87]
    v_mfma_f32_32x32x16_bf16 v[88:103], v[68:71], v[52:55], v[88:103]
    ds_read_b128 v[52:55], v7 offset:96
    ds_read_b128 v[64:67], v8 offset:96
    ds_read_b128 v[68:71], v8 offset:4704
    s_waitcnt lgkmcnt(3)
    v_mfma_f32_32x32x16_bf16 v[72:87], v[56:59], v[48:51], v[72:87]
    v_mfma_f32_32x32x16_bf16 v[88:103], v[60:63], v[48:51], v[88:103]
    s_waitcnt lgkmcnt(0)
    v_mfma_f32_32x32x16_bf16 v[72:87], v[64:67], v[52:55], v[72:87]
    v_mfma_f32_32x32x16_bf16 v[88:103], v[68:71], v[52:55], v[88:103]
    s_waitcnt vmcnt(6)
    ds_write_b128 v4, v[136:139] offset:38912
    ds_write_b128 v4, v[140:143] offset:43520
    ds_write_b128 v5, v[144:147] offset:38912
    ds_write_b128 v5, v[148:151] offset:43520
    ds_write_b128 v5, v[152:155] offset:48128
    ds_write_b128 v5, v[156:159] offset:52736
    s_waitcnt lgkmcnt(0)
    s_barrier
    s_mov_b32 s90, 384
    s_mov_b32 s91, 384
    buffer_load_dwordx4 v[136:139], v10, s[8:11], s90 offen
    buffer_load_dwordx4 v[140:143], v11, s[8:11], s90 offen
    buffer_load_dwordx4 v[144:147], v14, s[12:15], s91 offen
    buffer_load_dwordx4 v[148:151], v15, s[12:15], s91 offen
    buffer_load_dwordx4 v[152:155], v16, s[12:15], s91 offen
    buffer_load_dwordx4 v[156:159], v17, s[12:15], s91 offen
    ds_read_b128 v[48:51], v7 offset:38912
    ds_read_b128 v[56:59], v8 offset:38912
    ds_read_b128 v[60:63], v8 offset:43520
    ds_read_b128 v[52:55], v7 offset:38944
    ds_read_b128 v[64:67], v8 offset:38944
    ds_read_b128 v[68:71], v8 offset:43552
    s_waitcnt lgkmcnt(3)
    v_mfma_f32_32x32x16_bf16 v[72:87], v[56:59], v[48:51], v[72:87]
    v_mfma_f32_32x32x16_bf16 v[88:103], v[60:63], v[48:51], v[88:103]
    ds_read_b128 v[48:51], v7 offset:38976
    ds_read_b128 v[56:59], v8 offset:38976
    ds_read_b128 v[60:63], v8 offset:43584
    s_waitcnt lgkmcnt(3)
    v_mfma_f32_32x32x16_bf16 v[72:87], v[64:67], v[52:55], v[72:87]
    v_mfma_f32_32x32x16_bf16 v[88:103], v[68:71], v[52:55], v[88:103]
    ds_read_b128 v[52:55], v7 offset:39008
    ds_read_b128 v[64:67], v8 offset:39008
    ds_read_b128 v[68:71], v8 offset:43616
    s_waitcnt lgkmcnt(3)
    v_mfma_f32_32x32x16_bf16 v[72:87], v[56:59], v[48:51], v[72:87]
    v_mfma_f32_32x32x16_bf16 v[88:103], v[60:63], v[48:51], v[88:103]
    s_waitcnt lgkmcnt(0)
    v_mfma_f32_32x32x16_bf16 v[72:87], v[64:67], v[52:55], v[72:87]
    v_mfma_f32_32x32x16_bf16 v[88:103], v[68:71], v[52:55], v[88:103]
    s_waitcnt vmcnt(6)
    ds_write_b128 v4, v[24:27] offset:0
    ds_write_b128 v4, v[28:31] offset:4608
    ds_write_b128 v5, v[32:35] offset:0
    ds_write_b128 v5, v[36:39] offset:4608
    ds_write_b128 v5, v[40:43] offset:9216
    ds_write_b128 v5, v[44:47] offset:13824
    s_waitcnt lgkmcnt(0)
    s_barrier
    s_mov_b32 s90, 512
    s_mov_b32 s91, 512
    buffer_load_dwordx4 v[24:27], v10, s[8:11], s90 offen
    buffer_load_dwordx4 v[28:31], v11, s[8:11], s90 offen
    buffer_load_dwordx4 v[32:35], v14, s[12:15], s91 offen
    buffer_load_dwordx4 v[36:39], v15, s[12:15], s91 offen
    buffer_load_dwordx4 v[40:43], v16, s[12:15], s91 offen
    buffer_load_dwordx4 v[44:47], v17, s[12:15], s91 offen
    ds_read_b128 v[48:51], v7 offset:0
    ds_read_b128 v[56:59], v8 offset:0
    ds_read_b128 v[60:63], v8 offset:4608
    ds_read_b128 v[52:55], v7 offset:32
    ds_read_b128 v[64:67], v8 offset:32
    ds_read_b128 v[68:71], v8 offset:4640
    s_waitcnt lgkmcnt(3)
    v_mfma_f32_32x32x16_bf16 v[72:87], v[56:59], v[48:51], v[72:87]
    v_mfma_f32_32x32x16_bf16 v[88:103], v[60:63], v[48:51], v[88:103]
    ds_read_b128 v[48:51], v7 offset:64
    ds_read_b128 v[56:59], v8 offset:64
    ds_read_b128 v[60:63], v8 offset:4672
    s_waitcnt lgkmcnt(3)
    v_mfma_f32_32x32x16_bf16 v[72:87], v[64:67], v[52:55], v[72:87]
    v_mfma_f32_32x32x16_bf16 v[88:103], v[68:71], v[52:55], v[88:103]
    ds_read_b128 v[52:55], v7 offset:96
    ds_read_b128 v[64:67], v8 offset:96
    ds_read_b128 v[68:71], v8 offset:4704
    s_waitcnt lgkmcnt(3)
    v_mfma_f32_32x32x16_bf16 v[72:87], v[56:59], v[48:51], v[72:87]
    v_mfma_f32_32x32x16_bf16 v[88:103], v[60:63], v[48:51], v[88:103]
    s_waitcnt lgkmcnt(0)
    v_mfma_f32_32x32x16_bf16 v[72:87], v[64:67], v[52:55], v[72:87]
    v_mfma_f32_32x32x16_bf16 v[88:103], v[68:71], v[52:55], v[88:103]
    s_waitcnt vmcnt(6)
    ds_write_b128 v4, v[136:139] offset:38912
    ds_write_b128 v4, v[140:143] offset:43520
    ds_write_b128 v5, v[144:147] offset:38912
    ds_write_b128 v5, v[148:151] offset:43520
    ds_write_b128 v5, v[152:155] offset:48128
    ds_write_b128 v5, v[156:159] offset:52736
    s_waitcnt lgkmcnt(0)
    s_barrier
    s_mov_b32 s90, 640
    s_mov_b32 s91, 640
    buffer_load_dwordx4 v[136:139], v10, s[8:11], s90 offen
    buffer_load_dwordx4 v[140:143], v11, s[8:11], s90 offen
    buffer_load_dwordx4 v[144:147], v14, s[12:15], s91 offen
    buffer_load_dwordx4 v[148:151], v15, s[12:15], s91 offen
    buffer_load_dwordx4 v[152:155], v16, s[12:15], s91 offen
    buffer_load_dwordx4 v[156:159], v17, s[12:15], s91 offen
    ds_read_b128 v[48:51], v7 offset:38912
    ds_read_b128 v[56:59], v8 offset:38912
    ds_read_b128 v[60:63], v8 offset:43520
    ds_read_b128 v[52:55], v7 offset:38944
    ds_read_b128 v[64:67], v8 offset:38944
    ds_read_b128 v[68:71], v8 offset:43552
    s_waitcnt lgkmcnt(3)
    v_mfma_f32_32x32x16_bf16 v[72:87], v[56:59], v[48:51], v[72:87]
    v_mfma_f32_32x32x16_bf16 v[88:103], v[60:63], v[48:51], v[88:103]
    ds_read_b128 v[48:51], v7 offset:38976
    ds_read_b128 v[56:59], v8 offset:38976
    ds_read_b128 v[60:63], v8 offset:43584
    s_waitcnt lgkmcnt(3)
    v_mfma_f32_32x32x16_bf16 v[72:87], v[64:67], v[52:55], v[72:87]
    v_mfma_f32_32x32x16_bf16 v[88:103], v[68:71], v[52:55], v[88:103]
    ds_read_b128 v[52:55], v7 offset:39008
    ds_read_b128 v[64:67], v8 offset:39008
    ds_read_b128 v[68:71], v8 offset:43616
    s_waitcnt lgkmcnt(3)
    v_mfma_f32_32x32x16_bf16 v[72:87], v[56:59], v[48:51], v[72:87]
    v_mfma_f32_32x32x16_bf16 v[88:103], v[60:63], v[48:51], v[88:103]
    s_waitcnt lgkmcnt(0)
    v_mfma_f32_32x32x16_bf16 v[72:87], v[64:67], v[52:55], v[72:87]
    v_mfma_f32_32x32x16_bf16 v[88:103], v[68:71], v[52:55], v[88:103]
    s_waitcnt vmcnt(6)
    ds_write_b128 v4, v[24:27] offset:0
    ds_write_b128 v4, v[28:31] offset:4608
    ds_write_b128 v5, v[32:35] offset:0
    ds_write_b128 v5, v[36:39] offset:4608
    ds_write_b128 v5, v[40:43] offset:9216
    ds_write_b128 v5, v[44:47] offset:13824
    s_waitcnt lgkmcnt(0)
    s_barrier
    s_mov_b32 s90, 768
    s_mov_b32 s91, 768
    buffer_load_dwordx4 v[24:27], v10, s[8:11], s90 offen
    buffer_load_dwordx4 v[28:31], v11, s[8:11], s90 offen
    buffer_load_dwordx4 v[32:35], v14, s[12:15], s91 offen
    buffer_load_dwordx4 v[36:39], v15, s[12:15], s91 offen
    buffer_load_dwordx4 v[40:43], v16, s[12:15], s91 offen
    buffer_load_dwordx4 v[44:47], v17, s[12:15], s91 offen
    ds_read_b128 v[48:51], v7 offset:0
    ds_read_b128 v[56:59], v8 offset:0
    ds_read_b128 v[60:63], v8 offset:4608
    ds_read_b128 v[52:55], v7 offset:32
    ds_read_b128 v[64:67], v8 offset:32
    ds_read_b128 v[68:71], v8 offset:4640
    s_waitcnt lgkmcnt(3)
    v_mfma_f32_32x32x16_bf16 v[72:87], v[56:59], v[48:51], v[72:87]
    v_mfma_f32_32x32x16_bf16 v[88:103], v[60:63], v[48:51], v[88:103]
    ds_read_b128 v[48:51], v7 offset:64
    ds_read_b128 v[56:59], v8 offset:64
    ds_read_b128 v[60:63], v8 offset:4672
    s_waitcnt lgkmcnt(3)
    v_mfma_f32_32x32x16_bf16 v[72:87], v[64:67], v[52:55], v[72:87]
    v_mfma_f32_32x32x16_bf16 v[88:103], v[68:71], v[52:55], v[88:103]
    ds_read_b128 v[52:55], v7 offset:96
    ds_read_b128 v[64:67], v8 offset:96
    ds_read_b128 v[68:71], v8 offset:4704
    s_waitcnt lgkmcnt(3)
    v_mfma_f32_32x32x16_bf16 v[72:87], v[56:59], v[48:51], v[72:87]
    v_mfma_f32_32x32x16_bf16 v[88:103], v[60:63], v[48:51], v[88:103]
    s_waitcnt lgkmcnt(0)
    v_mfma_f32_32x32x16_bf16 v[72:87], v[64:67], v[52:55], v[72:87]
    v_mfma_f32_32x32x16_bf16 v[88:103], v[68:71], v[52:55], v[88:103]
    s_waitcnt vmcnt(6)
    ds_write_b128 v4, v[136:139] offset:38912
    ds_write_b128 v4, v[140:143] offset:43520
    ds_write_b128 v5, v[144:147] offset:38912
    ds_write_b128 v5, v[148:151] offset:43520
    ds_write_b128 v5, v[152:155] offset:48128
    ds_write_b128 v5, v[156:159] offset:52736
    s_waitcnt lgkmcnt(0)
    s_barrier
    s_mov_b32 s90, 896
    s_mov_b32 s91, 896
    buffer_load_dwordx4 v[136:139], v10, s[8:11], s90 offen
    buffer_load_dwordx4 v[140:143], v11, s[8:11], s90 offen
    buffer_load_dwordx4 v[144:147], v14, s[12:15], s91 offen
    buffer_load_dwordx4 v[148:151], v15, s[12:15], s91 offen
    buffer_load_dwordx4 v[152:155], v16, s[12:15], s91 offen
    buffer_load_dwordx4 v[156:159], v17, s[12:15], s91 offen
    ds_read_b128 v[48:51], v7 offset:38912
    ds_read_b128 v[56:59], v8 offset:38912
    ds_read_b128 v[60:63], v8 offset:43520
    ds_read_b128 v[52:55], v7 offset:38944
    ds_read_b128 v[64:67], v8 offset:38944
    ds_read_b128 v[68:71], v8 offset:43552
    s_waitcnt lgkmcnt(3)
    v_mfma_f32_32x32x16_bf16 v[72:87], v[56:59], v[48:51], v[72:87]
    v_mfma_f32_32x32x16_bf16 v[88:103], v[60:63], v[48:51], v[88:103]
    ds_read_b128 v[48:51], v7 offset:38976
    ds_read_b128 v[56:59], v8 offset:38976
    ds_read_b128 v[60:63], v8 offset:43584
    s_waitcnt lgkmcnt(3)
    v_mfma_f32_32x32x16_bf16 v[72:87], v[64:67], v[52:55], v[72:87]
    v_mfma_f32_32x32x16_bf16 v[88:103], v[68:71], v[52:55], v[88:103]
    ds_read_b128 v[52:55], v7 offset:39008
    ds_read_b128 v[64:67], v8 offset:39008
    ds_read_b128 v[68:71], v8 offset:43616
    s_waitcnt lgkmcnt(3)
    v_mfma_f32_32x32x16_bf16 v[72:87], v[56:59], v[48:51], v[72:87]
    v_mfma_f32_32x32x16_bf16 v[88:103], v[60:63], v[48:51], v[88:103]
    s_waitcnt lgkmcnt(0)
    v_mfma_f32_32x32x16_bf16 v[72:87], v[64:67], v[52:55], v[72:87]
    v_mfma_f32_32x32x16_bf16 v[88:103], v[68:71], v[52:55], v[88:103]
    s_waitcnt vmcnt(6)
    ds_write_b128 v4, v[24:27] offset:0
    ds_write_b128 v4, v[28:31] offset:4608
    ds_write_b128 v5, v[32:35] offset:0
    ds_write_b128 v5, v[36:39] offset:4608
    ds_write_b128 v5, v[40:43] offset:9216
    ds_write_b128 v5, v[44:47] offset:13824
    s_waitcnt lgkmcnt(0)
    s_barrier
    s_mov_b32 s90, 1024
    s_mov_b32 s91, 1024
    buffer_load_dwordx4 v[24:27], v10, s[8:11], s90 offen
    buffer_load_dwordx4 v[28:31], v11, s[8:11], s90 offen
    buffer_load_dwordx4 v[32:35], v14, s[12:15], s91 offen
    buffer_load_dwordx4 v[36:39], v15, s[12:15], s91 offen
    buffer_load_dwordx4 v[40:43], v16, s[12:15], s91 offen
    buffer_load_dwordx4 v[44:47], v17, s[12:15], s91 offen
    ds_read_b128 v[48:51], v7 offset:0
    ds_read_b128 v[56:59], v8 offset:0
    ds_read_b128 v[60:63], v8 offset:4608
    ds_read_b128 v[52:55], v7 offset:32
    ds_read_b128 v[64:67], v8 offset:32
    ds_read_b128 v[68:71], v8 offset:4640
    s_waitcnt lgkmcnt(3)
    v_mfma_f32_32x32x16_bf16 v[72:87], v[56:59], v[48:51], v[72:87]
    v_mfma_f32_32x32x16_bf16 v[88:103], v[60:63], v[48:51], v[88:103]
    ds_read_b128 v[48:51], v7 offset:64
    ds_read_b128 v[56:59], v8 offset:64
    ds_read_b128 v[60:63], v8 offset:4672
    s_waitcnt lgkmcnt(3)
    v_mfma_f32_32x32x16_bf16 v[72:87], v[64:67], v[52:55], v[72:87]
    v_mfma_f32_32x32x16_bf16 v[88:103], v[68:71], v[52:55], v[88:103]
    ds_read_b128 v[52:55], v7 offset:96
    ds_read_b128 v[64:67], v8 offset:96
    ds_read_b128 v[68:71], v8 offset:4704
    s_waitcnt lgkmcnt(3)
    v_mfma_f32_32x32x16_bf16 v[72:87], v[56:59], v[48:51], v[72:87]
    v_mfma_f32_32x32x16_bf16 v[88:103], v[60:63], v[48:51], v[88:103]
    s_waitcnt lgkmcnt(0)
    v_mfma_f32_32x32x16_bf16 v[72:87], v[64:67], v[52:55], v[72:87]
    v_mfma_f32_32x32x16_bf16 v[88:103], v[68:71], v[52:55], v[88:103]
    s_waitcnt vmcnt(6)
    ds_write_b128 v4, v[136:139] offset:38912
    ds_write_b128 v4, v[140:143] offset:43520
    ds_write_b128 v5, v[144:147] offset:38912
    ds_write_b128 v5, v[148:151] offset:43520
    ds_write_b128 v5, v[152:155] offset:48128
    ds_write_b128 v5, v[156:159] offset:52736
    s_waitcnt lgkmcnt(0)
    s_barrier
    s_mov_b32 s90, 1152
    s_mov_b32 s91, 1152
    buffer_load_dwordx4 v[136:139], v10, s[8:11], s90 offen
    buffer_load_dwordx4 v[140:143], v11, s[8:11], s90 offen
    buffer_load_dwordx4 v[144:147], v14, s[12:15], s91 offen
    buffer_load_dwordx4 v[148:151], v15, s[12:15], s91 offen
    buffer_load_dwordx4 v[152:155], v16, s[12:15], s91 offen
    buffer_load_dwordx4 v[156:159], v17, s[12:15], s91 offen
    ds_read_b128 v[48:51], v7 offset:38912
    ds_read_b128 v[56:59], v8 offset:38912
    ds_read_b128 v[60:63], v8 offset:43520
    ds_read_b128 v[52:55], v7 offset:38944
    ds_read_b128 v[64:67], v8 offset:38944
    ds_read_b128 v[68:71], v8 offset:43552
    s_waitcnt lgkmcnt(3)
    v_mfma_f32_32x32x16_bf16 v[72:87], v[56:59], v[48:51], v[72:87]
    v_mfma_f32_32x32x16_bf16 v[88:103], v[60:63], v[48:51], v[88:103]
    ds_read_b128 v[48:51], v7 offset:38976
    ds_read_b128 v[56:59], v8 offset:38976
    ds_read_b128 v[60:63], v8 offset:43584
    s_waitcnt lgkmcnt(3)
    v_mfma_f32_32x32x16_bf16 v[72:87], v[64:67], v[52:55], v[72:87]
    v_mfma_f32_32x32x16_bf16 v[88:103], v[68:71], v[52:55], v[88:103]
    ds_read_b128 v[52:55], v7 offset:39008
    ds_read_b128 v[64:67], v8 offset:39008
    ds_read_b128 v[68:71], v8 offset:43616
    s_waitcnt lgkmcnt(3)
    v_mfma_f32_32x32x16_bf16 v[72:87], v[56:59], v[48:51], v[72:87]
    v_mfma_f32_32x32x16_bf16 v[88:103], v[60:63], v[48:51], v[88:103]
    s_waitcnt lgkmcnt(0)
    v_mfma_f32_32x32x16_bf16 v[72:87], v[64:67], v[52:55], v[72:87]
    v_mfma_f32_32x32x16_bf16 v[88:103], v[68:71], v[52:55], v[88:103]
    s_waitcnt vmcnt(6)
    ds_write_b128 v4, v[24:27] offset:0
    ds_write_b128 v4, v[28:31] offset:4608
    ds_write_b128 v5, v[32:35] offset:0
    ds_write_b128 v5, v[36:39] offset:4608
    ds_write_b128 v5, v[40:43] offset:9216
    ds_write_b128 v5, v[44:47] offset:13824
    s_waitcnt lgkmcnt(0)
    s_barrier
    s_mov_b32 s90, 1280
    s_mov_b32 s91, 0
    buffer_load_dwordx4 v[24:27], v10, s[8:11], s90 offen
    buffer_load_dwordx4 v[28:31], v11, s[8:11], s90 offen
    buffer_load_dwordx4 v[32:35], v14, s[16:19], s91 offen
    buffer_load_dwordx4 v[36:39], v15, s[16:19], s91 offen
    buffer_load_dwordx4 v[40:43], v16, s[16:19], s91 offen
    buffer_load_dwordx4 v[44:47], v17, s[16:19], s91 offen
    ds_read_b128 v[48:51], v7 offset:0
    ds_read_b128 v[56:59], v8 offset:0
    ds_read_b128 v[60:63], v8 offset:4608
    ds_read_b128 v[52:55], v7 offset:32
    ds_read_b128 v[64:67], v8 offset:32
    ds_read_b128 v[68:71], v8 offset:4640
    s_waitcnt lgkmcnt(3)
    v_mfma_f32_32x32x16_bf16 v[72:87], v[56:59], v[48:51], v[72:87]
    v_mfma_f32_32x32x16_bf16 v[88:103], v[60:63], v[48:51], v[88:103]
    ds_read_b128 v[48:51], v7 offset:64
    ds_read_b128 v[56:59], v8 offset:64
    ds_read_b128 v[60:63], v8 offset:4672
    s_waitcnt lgkmcnt(3)
    v_mfma_f32_32x32x16_bf16 v[72:87], v[64:67], v[52:55], v[72:87]
    v_mfma_f32_32x32x16_bf16 v[88:103], v[68:71], v[52:55], v[88:103]
    ds_read_b128 v[52:55], v7 offset:96
    ds_read_b128 v[64:67], v8 offset:96
    ds_read_b128 v[68:71], v8 offset:4704
    s_waitcnt lgkmcnt(3)
    v_mfma_f32_32x32x16_bf16 v[72:87], v[56:59], v[48:51], v[72:87]
    v_mfma_f32_32x32x16_bf16 v[88:103], v[60:63], v[48:51], v[88:103]
    s_waitcnt lgkmcnt(0)
    v_mfma_f32_32x32x16_bf16 v[72:87], v[64:67], v[52:55], v[72:87]
    v_mfma_f32_32x32x16_bf16 v[88:103], v[68:71], v[52:55], v[88:103]
    s_waitcnt vmcnt(6)
    ds_write_b128 v4, v[136:139] offset:38912
    ds_write_b128 v4, v[140:143] offset:43520
    ds_write_b128 v5, v[144:147] offset:38912
    ds_write_b128 v5, v[148:151] offset:43520
    ds_write_b128 v5, v[152:155] offset:48128
    ds_write_b128 v5, v[156:159] offset:52736
    s_waitcnt lgkmcnt(0)
    s_barrier
    s_mov_b32 s90, 1408
    s_mov_b32 s91, 128
    buffer_load_dwordx4 v[136:139], v10, s[8:11], s90 offen
    buffer_load_dwordx4 v[140:143], v11, s[8:11], s90 offen
    buffer_load_dwordx4 v[144:147], v14, s[16:19], s91 offen
    buffer_load_dwordx4 v[148:151], v15, s[16:19], s91 offen
    buffer_load_dwordx4 v[152:155], v16, s[16:19], s91 offen
    buffer_load_dwordx4 v[156:159], v17, s[16:19], s91 offen
    ds_read_b128 v[48:51], v7 offset:38912
    ds_read_b128 v[56:59], v8 offset:38912
    ds_read_b128 v[60:63], v8 offset:43520
    ds_read_b128 v[52:55], v7 offset:38944
    ds_read_b128 v[64:67], v8 offset:38944
    ds_read_b128 v[68:71], v8 offset:43552
    s_waitcnt lgkmcnt(3)
    v_mfma_f32_32x32x16_bf16 v[72:87], v[56:59], v[48:51], v[72:87]
    v_mfma_f32_32x32x16_bf16 v[88:103], v[60:63], v[48:51], v[88:103]
    ds_read_b128 v[48:51], v7 offset:38976
    ds_read_b128 v[56:59], v8 offset:38976
    ds_read_b128 v[60:63], v8 offset:43584
    s_waitcnt lgkmcnt(3)
    v_mfma_f32_32x32x16_bf16 v[72:87], v[64:67], v[52:55], v[72:87]
    v_mfma_f32_32x32x16_bf16 v[88:103], v[68:71], v[52:55], v[88:103]
    ds_read_b128 v[52:55], v7 offset:39008
    ds_read_b128 v[64:67], v8 offset:39008
    ds_read_b128 v[68:71], v8 offset:43616
    s_waitcnt lgkmcnt(3)
    v_mfma_f32_32x32x16_bf16 v[72:87], v[56:59], v[48:51], v[72:87]
    v_mfma_f32_32x32x16_bf16 v[88:103], v[60:63], v[48:51], v[88:103]
    s_waitcnt lgkmcnt(0)
    v_mfma_f32_32x32x16_bf16 v[72:87], v[64:67], v[52:55], v[72:87]
    v_mfma_f32_32x32x16_bf16 v[88:103], v[68:71], v[52:55], v[88:103]
    s_waitcnt vmcnt(6)
    ds_write_b128 v4, v[24:27] offset:0
    ds_write_b128 v4, v[28:31] offset:4608
    ds_write_b128 v5, v[32:35] offset:0
    ds_write_b128 v5, v[36:39] offset:4608
    ds_write_b128 v5, v[40:43] offset:9216
    ds_write_b128 v5, v[44:47] offset:13824
    s_waitcnt lgkmcnt(0)
    s_barrier
    s_mov_b32 s90, 1536
    s_mov_b32 s91, 256
    buffer_load_dwordx4 v[24:27], v10, s[8:11], s90 offen
    buffer_load_dwordx4 v[28:31], v11, s[8:11], s90 offen
    buffer_load_dwordx4 v[32:35], v14, s[16:19], s91 offen
    buffer_load_dwordx4 v[36:39], v15, s[16:19], s91 offen
    buffer_load_dwordx4 v[40:43], v16, s[16:19], s91 offen
    buffer_load_dwordx4 v[44:47], v17, s[16:19], s91 offen
    ds_read_b128 v[48:51], v7 offset:0
    ds_read_b128 v[56:59], v8 offset:0
    ds_read_b128 v[60:63], v8 offset:4608
    ds_read_b128 v[52:55], v7 offset:32
    ds_read_b128 v[64:67], v8 offset:32
    ds_read_b128 v[68:71], v8 offset:4640
    s_waitcnt lgkmcnt(3)
    v_mfma_f32_32x32x16_bf16 v[72:87], v[56:59], v[48:51], v[72:87]
    v_mfma_f32_32x32x16_bf16 v[88:103], v[60:63], v[48:51], v[88:103]
    ds_read_b128 v[48:51], v7 offset:64
    ds_read_b128 v[56:59], v8 offset:64
    ds_read_b128 v[60:63], v8 offset:4672
    s_waitcnt lgkmcnt(3)
    v_mfma_f32_32x32x16_bf16 v[72:87], v[64:67], v[52:55], v[72:87]
    v_mfma_f32_32x32x16_bf16 v[88:103], v[68:71], v[52:55], v[88:103]
    ds_read_b128 v[52:55], v7 offset:96
    ds_read_b128 v[64:67], v8 offset:96
    ds_read_b128 v[68:71], v8 offset:4704
    s_waitcnt lgkmcnt(3)
    v_mfma_f32_32x32x16_bf16 v[72:87], v[56:59], v[48:51], v[72:87]
    v_mfma_f32_32x32x16_bf16 v[88:103], v[60:63], v[48:51], v[88:103]
    s_waitcnt lgkmcnt(0)
    v_mfma_f32_32x32x16_bf16 v[72:87], v[64:67], v[52:55], v[72:87]
    v_mfma_f32_32x32x16_bf16 v[88:103], v[68:71], v[52:55], v[88:103]
    s_waitcnt vmcnt(6)
    ds_write_b128 v4, v[136:139] offset:38912
    ds_write_b128 v4, v[140:143] offset:43520
    ds_write_b128 v5, v[144:147] offset:38912
    ds_write_b128 v5, v[148:151] offset:43520
    ds_write_b128 v5, v[152:155] offset:48128
    ds_write_b128 v5, v[156:159] offset:52736
    s_waitcnt lgkmcnt(0)
    s_barrier
    s_mov_b32 s90, 1664
    s_mov_b32 s91, 384
    buffer_load_dwordx4 v[136:139], v10, s[8:11], s90 offen
    buffer_load_dwordx4 v[140:143], v11, s[8:11], s90 offen
    buffer_load_dwordx4 v[144:147], v14, s[16:19], s91 offen
    buffer_load_dwordx4 v[148:151], v15, s[16:19], s91 offen
    buffer_load_dwordx4 v[152:155], v16, s[16:19], s91 offen
    buffer_load_dwordx4 v[156:159], v17, s[16:19], s91 offen
    ds_read_b128 v[48:51], v7 offset:38912
    ds_read_b128 v[56:59], v8 offset:38912
    ds_read_b128 v[60:63], v8 offset:43520
    ds_read_b128 v[52:55], v7 offset:38944
    ds_read_b128 v[64:67], v8 offset:38944
    ds_read_b128 v[68:71], v8 offset:43552
    s_waitcnt lgkmcnt(3)
    v_mfma_f32_32x32x16_bf16 v[72:87], v[56:59], v[48:51], v[72:87]
    v_mfma_f32_32x32x16_bf16 v[88:103], v[60:63], v[48:51], v[88:103]
    ds_read_b128 v[48:51], v7 offset:38976
    ds_read_b128 v[56:59], v8 offset:38976
    ds_read_b128 v[60:63], v8 offset:43584
    s_waitcnt lgkmcnt(3)
    v_mfma_f32_32x32x16_bf16 v[72:87], v[64:67], v[52:55], v[72:87]
    v_mfma_f32_32x32x16_bf16 v[88:103], v[68:71], v[52:55], v[88:103]
    ds_read_b128 v[52:55], v7 offset:39008
    ds_read_b128 v[64:67], v8 offset:39008
    ds_read_b128 v[68:71], v8 offset:43616
    s_waitcnt lgkmcnt(3)
    v_mfma_f32_32x32x16_bf16 v[72:87], v[56:59], v[48:51], v[72:87]
    v_mfma_f32_32x32x16_bf16 v[88:103], v[60:63], v[48:51], v[88:103]
    s_waitcnt lgkmcnt(0)
    v_mfma_f32_32x32x16_bf16 v[72:87], v[64:67], v[52:55], v[72:87]
    v_mfma_f32_32x32x16_bf16 v[88:103], v[68:71], v[52:55], v[88:103]
    s_waitcnt vmcnt(6)
    ds_write_b128 v4, v[24:27] offset:0
    ds_write_b128 v4, v[28:31] offset:4608
    ds_write_b128 v5, v[32:35] offset:0
    ds_write_b128 v5, v[36:39] offset:4608
    ds_write_b128 v5, v[40:43] offset:9216
    ds_write_b128 v5, v[44:47] offset:13824
    s_waitcnt lgkmcnt(0)
    s_barrier
    s_mov_b32 s90, 1792
    s_mov_b32 s91, 512
    buffer_load_dwordx4 v[24:27], v10, s[8:11], s90 offen
    buffer_load_dwordx4 v[28:31], v11, s[8:11], s90 offen
    buffer_load_dwordx4 v[32:35], v14, s[16:19], s91 offen
    buffer_load_dwordx4 v[36:39], v15, s[16:19], s91 offen
    buffer_load_dwordx4 v[40:43], v16, s[16:19], s91 offen
    buffer_load_dwordx4 v[44:47], v17, s[16:19], s91 offen
    ds_read_b128 v[48:51], v7 offset:0
    ds_read_b128 v[56:59], v8 offset:0
    ds_read_b128 v[60:63], v8 offset:4608
    ds_read_b128 v[52:55], v7 offset:32
    ds_read_b128 v[64:67], v8 offset:32
    ds_read_b128 v[68:71], v8 offset:4640
    s_waitcnt lgkmcnt(3)
    v_mfma_f32_32x32x16_bf16 v[72:87], v[56:59], v[48:51], v[72:87]
    v_mfma_f32_32x32x16_bf16 v[88:103], v[60:63], v[48:51], v[88:103]
    ds_read_b128 v[48:51], v7 offset:64
    ds_read_b128 v[56:59], v8 offset:64
    ds_read_b128 v[60:63], v8 offset:4672
    s_waitcnt lgkmcnt(3)
    v_mfma_f32_32x32x16_bf16 v[72:87], v[64:67], v[52:55], v[72:87]
    v_mfma_f32_32x32x16_bf16 v[88:103], v[68:71], v[52:55], v[88:103]
    ds_read_b128 v[52:55], v7 offset:96
    ds_read_b128 v[64:67], v8 offset:96
    ds_read_b128 v[68:71], v8 offset:4704
    s_waitcnt lgkmcnt(3)
    v_mfma_f32_32x32x16_bf16 v[72:87], v[56:59], v[48:51], v[72:87]
    v_mfma_f32_32x32x16_bf16 v[88:103], v[60:63], v[48:51], v[88:103]
    s_waitcnt lgkmcnt(0)
    v_mfma_f32_32x32x16_bf16 v[72:87], v[64:67], v[52:55], v[72:87]
    v_mfma_f32_32x32x16_bf16 v[88:103], v[68:71], v[52:55], v[88:103]
    s_waitcnt vmcnt(6)
    ds_write_b128 v4, v[136:139] offset:38912
    ds_write_b128 v4, v[140:143] offset:43520
    ds_write_b128 v5, v[144:147] offset:38912
    ds_write_b128 v5, v[148:151] offset:43520
    ds_write_b128 v5, v[152:155] offset:48128
    ds_write_b128 v5, v[156:159] offset:52736
    s_waitcnt lgkmcnt(0)
    s_barrier
    s_mov_b32 s90, 1920
    s_mov_b32 s91, 640
    buffer_load_dwordx4 v[136:139], v10, s[8:11], s90 offen
    buffer_load_dwordx4 v[140:143], v11, s[8:11], s90 offen
    buffer_load_dwordx4 v[144:147], v14, s[16:19], s91 offen
    buffer_load_dwordx4 v[148:151], v15, s[16:19], s91 offen
    buffer_load_dwordx4 v[152:155], v16, s[16:19], s91 offen
    buffer_load_dwordx4 v[156:159], v17, s[16:19], s91 offen
    ds_read_b128 v[48:51], v7 offset:38912
    ds_read_b128 v[56:59], v8 offset:38912
    ds_read_b128 v[60:63], v8 offset:43520
    ds_read_b128 v[52:55], v7 offset:38944
    ds_read_b128 v[64:67], v8 offset:38944
    ds_read_b128 v[68:71], v8 offset:43552
    s_waitcnt lgkmcnt(3)
    v_mfma_f32_32x32x16_bf16 v[72:87], v[56:59], v[48:51], v[72:87]
    v_mfma_f32_32x32x16_bf16 v[88:103], v[60:63], v[48:51], v[88:103]
    ds_read_b128 v[48:51], v7 offset:38976
    ds_read_b128 v[56:59], v8 offset:38976
    ds_read_b128 v[60:63], v8 offset:43584
    s_waitcnt lgkmcnt(3)
    v_mfma_f32_32x32x16_bf16 v[72:87], v[64:67], v[52:55], v[72:87]
    v_mfma_f32_32x32x16_bf16 v[88:103], v[68:71], v[52:55], v[88:103]
    ds_read_b128 v[52:55], v7 offset:39008
    ds_read_b128 v[64:67], v8 offset:39008
    ds_read_b128 v[68:71], v8 offset:43616
    s_waitcnt lgkmcnt(3)
    v_mfma_f32_32x32x16_bf16 v[72:87], v[56:59], v[48:51], v[72:87]
    v_mfma_f32_32x32x16_bf16 v[88:103], v[60:63], v[48:51], v[88:103]
    s_waitcnt lgkmcnt(0)
    v_mfma_f32_32x32x16_bf16 v[72:87], v[64:67], v[52:55], v[72:87]
    v_mfma_f32_32x32x16_bf16 v[88:103], v[68:71], v[52:55], v[88:103]
    s_waitcnt vmcnt(6)
    ds_write_b128 v4, v[24:27] offset:0
    ds_write_b128 v4, v[28:31] offset:4608
    ds_write_b128 v5, v[32:35] offset:0
    ds_write_b128 v5, v[36:39] offset:4608
    ds_write_b128 v5, v[40:43] offset:9216
    ds_write_b128 v5, v[44:47] offset:13824
    s_waitcnt lgkmcnt(0)
    s_barrier
    s_mov_b32 s90, 2048
    s_mov_b32 s91, 768
    buffer_load_dwordx4 v[24:27], v10, s[8:11], s90 offen
    buffer_load_dwordx4 v[28:31], v11, s[8:11], s90 offen
    buffer_load_dwordx4 v[32:35], v14, s[16:19], s91 offen
    buffer_load_dwordx4 v[36:39], v15, s[16:19], s91 offen
    buffer_load_dwordx4 v[40:43], v16, s[16:19], s91 offen
    buffer_load_dwordx4 v[44:47], v17, s[16:19], s91 offen
    ds_read_b128 v[48:51], v7 offset:0
    ds_read_b128 v[56:59], v8 offset:0
    ds_read_b128 v[60:63], v8 offset:4608
    ds_read_b128 v[52:55], v7 offset:32
    ds_read_b128 v[64:67], v8 offset:32
    ds_read_b128 v[68:71], v8 offset:4640
    s_waitcnt lgkmcnt(3)
    v_mfma_f32_32x32x16_bf16 v[72:87], v[56:59], v[48:51], v[72:87]
    v_mfma_f32_32x32x16_bf16 v[88:103], v[60:63], v[48:51], v[88:103]
    ds_read_b128 v[48:51], v7 offset:64
    ds_read_b128 v[56:59], v8 offset:64
    ds_read_b128 v[60:63], v8 offset:4672
    s_waitcnt lgkmcnt(3)
    v_mfma_f32_32x32x16_bf16 v[72:87], v[64:67], v[52:55], v[72:87]
    v_mfma_f32_32x32x16_bf16 v[88:103], v[68:71], v[52:55], v[88:103]
    ds_read_b128 v[52:55], v7 offset:96
    ds_read_b128 v[64:67], v8 offset:96
    ds_read_b128 v[68:71], v8 offset:4704
    s_waitcnt lgkmcnt(3)
    v_mfma_f32_32x32x16_bf16 v[72:87], v[56:59], v[48:51], v[72:87]
    v_mfma_f32_32x32x16_bf16 v[88:103], v[60:63], v[48:51], v[88:103]
    s_waitcnt lgkmcnt(0)
    v_mfma_f32_32x32x16_bf16 v[72:87], v[64:67], v[52:55], v[72:87]
    v_mfma_f32_32x32x16_bf16 v[88:103], v[68:71], v[52:55], v[88:103]
    s_waitcnt vmcnt(6)
    ds_write_b128 v4, v[136:139] offset:38912
    ds_write_b128 v4, v[140:143] offset:43520
    ds_write_b128 v5, v[144:147] offset:38912
    ds_write_b128 v5, v[148:151] offset:43520
    ds_write_b128 v5, v[152:155] offset:48128
    ds_write_b128 v5, v[156:159] offset:52736
    s_waitcnt lgkmcnt(0)
    s_barrier
    s_mov_b32 s90, 2176
    s_mov_b32 s91, 896
    buffer_load_dwordx4 v[136:139], v10, s[8:11], s90 offen
    buffer_load_dwordx4 v[140:143], v11, s[8:11], s90 offen
    buffer_load_dwordx4 v[144:147], v14, s[16:19], s91 offen
    buffer_load_dwordx4 v[148:151], v15, s[16:19], s91 offen
    buffer_load_dwordx4 v[152:155], v16, s[16:19], s91 offen
    buffer_load_dwordx4 v[156:159], v17, s[16:19], s91 offen
    ds_read_b128 v[48:51], v7 offset:38912
    ds_read_b128 v[56:59], v8 offset:38912
    ds_read_b128 v[60:63], v8 offset:43520
    ds_read_b128 v[52:55], v7 offset:38944
    ds_read_b128 v[64:67], v8 offset:38944
    ds_read_b128 v[68:71], v8 offset:43552
    s_waitcnt lgkmcnt(3)
    v_mfma_f32_32x32x16_bf16 v[72:87], v[56:59], v[48:51], v[72:87]
    v_mfma_f32_32x32x16_bf16 v[88:103], v[60:63], v[48:51], v[88:103]
    ds_read_b128 v[48:51], v7 offset:38976
    ds_read_b128 v[56:59], v8 offset:38976
    ds_read_b128 v[60:63], v8 offset:43584
    s_waitcnt lgkmcnt(3)
    v_mfma_f32_32x32x16_bf16 v[72:87], v[64:67], v[52:55], v[72:87]
    v_mfma_f32_32x32x16_bf16 v[88:103], v[68:71], v[52:55], v[88:103]
    ds_read_b128 v[52:55], v7 offset:39008
    ds_read_b128 v[64:67], v8 offset:39008
    ds_read_b128 v[68:71], v8 offset:43616
    s_waitcnt lgkmcnt(3)
    v_mfma_f32_32x32x16_bf16 v[72:87], v[56:59], v[48:51], v[72:87]
    v_mfma_f32_32x32x16_bf16 v[88:103], v[60:63], v[48:51], v[88:103]
    s_waitcnt lgkmcnt(0)
    v_mfma_f32_32x32x16_bf16 v[72:87], v[64:67], v[52:55], v[72:87]
    v_mfma_f32_32x32x16_bf16 v[88:103], v[68:71], v[52:55], v[88:103]
    s_waitcnt vmcnt(6)
    ds_write_b128 v4, v[24:27] offset:0
    ds_write_b128 v4, v[28:31] offset:4608
    ds_write_b128 v5, v[32:35] offset:0
    ds_write_b128 v5, v[36:39] offset:4608
    ds_write_b128 v5, v[40:43] offset:9216
    ds_write_b128 v5, v[44:47] offset:13824
    s_waitcnt lgkmcnt(0)
    s_barrier
    s_mov_b32 s90, 2304
    s_mov_b32 s91, 1024
    buffer_load_dwordx4 v[24:27], v10, s[8:11], s90 offen
    buffer_load_dwordx4 v[28:31], v11, s[8:11], s90 offen
    buffer_load_dwordx4 v[32:35], v14, s[16:19], s91 offen
    buffer_load_dwordx4 v[36:39], v15, s[16:19], s91 offen
    buffer_load_dwordx4 v[40:43], v16, s[16:19], s91 offen
    buffer_load_dwordx4 v[44:47], v17, s[16:19], s91 offen
    ds_read_b128 v[48:51], v7 offset:0
    ds_read_b128 v[56:59], v8 offset:0
    ds_read_b128 v[60:63], v8 offset:4608
    ds_read_b128 v[52:55], v7 offset:32
    ds_read_b128 v[64:67], v8 offset:32
    ds_read_b128 v[68:71], v8 offset:4640
    s_waitcnt lgkmcnt(3)
    v_mfma_f32_32x32x16_bf16 v[72:87], v[56:59], v[48:51], v[72:87]
    v_mfma_f32_32x32x16_bf16 v[88:103], v[60:63], v[48:51], v[88:103]
    ds_read_b128 v[48:51], v7 offset:64
    ds_read_b128 v[56:59], v8 offset:64
    ds_read_b128 v[60:63], v8 offset:4672
    s_waitcnt lgkmcnt(3)
    v_mfma_f32_32x32x16_bf16 v[72:87], v[64:67], v[52:55], v[72:87]
    v_mfma_f32_32x32x16_bf16 v[88:103], v[68:71], v[52:55], v[88:103]
    ds_read_b128 v[52:55], v7 offset:96
    ds_read_b128 v[64:67], v8 offset:96
    ds_read_b128 v[68:71], v8 offset:4704
    s_waitcnt lgkmcnt(3)
    v_mfma_f32_32x32x16_bf16 v[72:87], v[56:59], v[48:51], v[72:87]
    v_mfma_f32_32x32x16_bf16 v[88:103], v[60:63], v[48:51], v[88:103]
    s_waitcnt lgkmcnt(0)
    v_mfma_f32_32x32x16_bf16 v[72:87], v[64:67], v[52:55], v[72:87]
    v_mfma_f32_32x32x16_bf16 v[88:103], v[68:71], v[52:55], v[88:103]
    s_waitcnt vmcnt(6)
    ds_write_b128 v4, v[136:139] offset:38912
    ds_write_b128 v4, v[140:143] offset:43520
    ds_write_b128 v5, v[144:147] offset:38912
    ds_write_b128 v5, v[148:151] offset:43520
    ds_write_b128 v5, v[152:155] offset:48128
    ds_write_b128 v5, v[156:159] offset:52736
    s_waitcnt lgkmcnt(0)
    s_barrier
    s_mov_b32 s90, 2432
    s_mov_b32 s91, 1152
    buffer_load_dwordx4 v[136:139], v10, s[8:11], s90 offen
    buffer_load_dwordx4 v[140:143], v11, s[8:11], s90 offen
    buffer_load_dwordx4 v[144:147], v14, s[16:19], s91 offen
    buffer_load_dwordx4 v[148:151], v15, s[16:19], s91 offen
    buffer_load_dwordx4 v[152:155], v16, s[16:19], s91 offen
    buffer_load_dwordx4 v[156:159], v17, s[16:19], s91 offen
    ds_read_b128 v[48:51], v7 offset:38912
    ds_read_b128 v[56:59], v8 offset:38912
    ds_read_b128 v[60:63], v8 offset:43520
    ds_read_b128 v[52:55], v7 offset:38944
    ds_read_b128 v[64:67], v8 offset:38944
    ds_read_b128 v[68:71], v8 offset:43552
    s_waitcnt lgkmcnt(3)
    v_mfma_f32_32x32x16_bf16 v[72:87], v[56:59], v[48:51], v[72:87]
    v_mfma_f32_32x32x16_bf16 v[88:103], v[60:63], v[48:51], v[88:103]
    ds_read_b128 v[48:51], v7 offset:38976
    ds_read_b128 v[56:59], v8 offset:38976
    ds_read_b128 v[60:63], v8 offset:43584
    s_waitcnt lgkmcnt(3)
    v_mfma_f32_32x32x16_bf16 v[72:87], v[64:67], v[52:55], v[72:87]
    v_mfma_f32_32x32x16_bf16 v[88:103], v[68:71], v[52:55], v[88:103]
    ds_read_b128 v[52:55], v7 offset:39008
    ds_read_b128 v[64:67], v8 offset:39008
    ds_read_b128 v[68:71], v8 offset:43616
    s_waitcnt lgkmcnt(3)
    v_mfma_f32_32x32x16_bf16 v[72:87], v[56:59], v[48:51], v[72:87]
    v_mfma_f32_32x32x16_bf16 v[88:103], v[60:63], v[48:51], v[88:103]
    s_waitcnt lgkmcnt(0)
    v_mfma_f32_32x32x16_bf16 v[72:87], v[64:67], v[52:55], v[72:87]
    v_mfma_f32_32x32x16_bf16 v[88:103], v[68:71], v[52:55], v[88:103]
    s_waitcnt vmcnt(6)
    ds_write_b128 v4, v[24:27] offset:0
    ds_write_b128 v4, v[28:31] offset:4608
    ds_write_b128 v5, v[32:35] offset:0
    ds_write_b128 v5, v[36:39] offset:4608
    ds_write_b128 v5, v[40:43] offset:9216
    ds_write_b128 v5, v[44:47] offset:13824
    s_waitcnt lgkmcnt(0)
    s_barrier
    s_mov_b32 s90, 0
    s_mov_b32 s91, 0
    buffer_load_dwordx4 v[24:27], v12, s[20:23], s90 offen
    buffer_load_dwordx4 v[28:31], v13, s[20:23], s90 offen
    buffer_load_dwordx4 v[32:35], v18, s[44:47], s91 offen
    buffer_load_dwordx4 v[36:39], v19, s[44:47], s91 offen
    buffer_load_dwordx4 v[40:43], v20, s[44:47], s91 offen
    buffer_load_dwordx4 v[44:47], v21, s[44:47], s91 offen
    ds_read_b128 v[48:51], v7 offset:0
    ds_read_b128 v[56:59], v8 offset:0
    ds_read_b128 v[60:63], v8 offset:4608
    ds_read_b128 v[52:55], v7 offset:32
    ds_read_b128 v[64:67], v8 offset:32
    ds_read_b128 v[68:71], v8 offset:4640
    s_waitcnt lgkmcnt(3)
    v_mfma_f32_32x32x16_bf16 v[72:87], v[56:59], v[48:51], v[72:87]
    v_mfma_f32_32x32x16_bf16 v[88:103], v[60:63], v[48:51], v[88:103]
    ds_read_b128 v[48:51], v7 offset:64
    ds_read_b128 v[56:59], v8 offset:64
    ds_read_b128 v[60:63], v8 offset:4672
    s_waitcnt lgkmcnt(3)
    v_mfma_f32_32x32x16_bf16 v[72:87], v[64:67], v[52:55], v[72:87]
    v_mfma_f32_32x32x16_bf16 v[88:103], v[68:71], v[52:55], v[88:103]
    ds_read_b128 v[52:55], v7 offset:96
    ds_read_b128 v[64:67], v8 offset:96
    ds_read_b128 v[68:71], v8 offset:4704
    s_waitcnt lgkmcnt(3)
    v_mfma_f32_32x32x16_bf16 v[72:87], v[56:59], v[48:51], v[72:87]
    v_mfma_f32_32x32x16_bf16 v[88:103], v[60:63], v[48:51], v[88:103]
    s_waitcnt lgkmcnt(0)
    v_mfma_f32_32x32x16_bf16 v[72:87], v[64:67], v[52:55], v[72:87]
    v_mfma_f32_32x32x16_bf16 v[88:103], v[68:71], v[52:55], v[88:103]
    s_waitcnt vmcnt(6)
    ds_write_b128 v4, v[136:139] offset:38912
    ds_write_b128 v4, v[140:143] offset:43520
    ds_write_b128 v5, v[144:147] offset:38912
    ds_write_b128 v5, v[148:151] offset:43520
    ds_write_b128 v5, v[152:155] offset:48128
    ds_write_b128 v5, v[156:159] offset:52736
    s_waitcnt lgkmcnt(0)
    s_barrier
    s_mov_b32 s90, 128
    s_mov_b32 s91, 81920
    buffer_load_dwordx4 v[136:139], v12, s[20:23], s90 offen
    buffer_load_dwordx4 v[140:143], v13, s[20:23], s90 offen
    buffer_load_dwordx4 v[144:147], v18, s[44:47], s91 offen
    buffer_load_dwordx4 v[148:151], v19, s[44:47], s91 offen
    buffer_load_dwordx4 v[152:155], v20, s[44:47], s91 offen
    buffer_load_dwordx4 v[156:159], v21, s[44:47], s91 offen
    ds_read_b128 v[48:51], v7 offset:38912
    ds_read_b128 v[56:59], v8 offset:38912
    ds_read_b128 v[60:63], v8 offset:43520
    ds_read_b128 v[52:55], v7 offset:38944
    ds_read_b128 v[64:67], v8 offset:38944
    ds_read_b128 v[68:71], v8 offset:43552
    s_waitcnt lgkmcnt(3)
    v_mfma_f32_32x32x16_bf16 v[72:87], v[56:59], v[48:51], v[72:87]
    v_mfma_f32_32x32x16_bf16 v[88:103], v[60:63], v[48:51], v[88:103]
    ds_read_b128 v[48:51], v7 offset:38976
    ds_read_b128 v[56:59], v8 offset:38976
    ds_read_b128 v[60:63], v8 offset:43584
    s_waitcnt lgkmcnt(3)
    v_mfma_f32_32x32x16_bf16 v[72:87], v[64:67], v[52:55], v[72:87]
    v_mfma_f32_32x32x16_bf16 v[88:103], v[68:71], v[52:55], v[88:103]
    ds_read_b128 v[52:55], v7 offset:39008
    ds_read_b128 v[64:67], v8 offset:39008
    ds_read_b128 v[68:71], v8 offset:43616
    s_waitcnt lgkmcnt(3)
    v_mfma_f32_32x32x16_bf16 v[72:87], v[56:59], v[48:51], v[72:87]
    v_mfma_f32_32x32x16_bf16 v[88:103], v[60:63], v[48:51], v[88:103]
    s_waitcnt lgkmcnt(0)
    v_mfma_f32_32x32x16_bf16 v[72:87], v[64:67], v[52:55], v[72:87]
    v_mfma_f32_32x32x16_bf16 v[88:103], v[68:71], v[52:55], v[88:103]
    s_waitcnt vmcnt(6)
    ds_write_b128 v4, v[24:27] offset:0
    ds_write_b128 v4, v[28:31] offset:4608
    ds_write_b128 v6, v[32:35] offset:0
    ds_write_b128 v6, v[36:39] offset:5120
    ds_write_b128 v6, v[40:43] offset:10240
    ds_write_b128 v6, v[44:47] offset:15360
    s_waitcnt lgkmcnt(0)
    s_barrier
    s_mov_b32 s90, 256
    s_mov_b32 s91, 163840
    buffer_load_dwordx4 v[24:27], v12, s[20:23], s90 offen
    buffer_load_dwordx4 v[28:31], v13, s[20:23], s90 offen
    buffer_load_dwordx4 v[32:35], v18, s[44:47], s91 offen
    buffer_load_dwordx4 v[36:39], v19, s[44:47], s91 offen
    buffer_load_dwordx4 v[40:43], v20, s[44:47], s91 offen
    buffer_load_dwordx4 v[44:47], v21, s[44:47], s91 offen
    ds_read_b128 v[48:51], v7 offset:0
    ds_read_b64_tr_b16 v[56:57], v9 offset:0
    ds_read_b64_tr_b16 v[58:59], v9 offset:1280
    ds_read_b64_tr_b16 v[60:61], v9 offset:64
    ds_read_b64_tr_b16 v[62:63], v9 offset:1344
    ds_read_b128 v[52:55], v7 offset:32
    ds_read_b64_tr_b16 v[64:65], v9 offset:5120
    ds_read_b64_tr_b16 v[66:67], v9 offset:6400
    ds_read_b64_tr_b16 v[68:69], v9 offset:5184
    ds_read_b64_tr_b16 v[70:71], v9 offset:6464
    s_waitcnt lgkmcnt(5)
    v_mfma_f32_32x32x16_bf16 v[104:119], v[56:59], v[48:51], v[104:119]
    v_mfma_f32_32x32x16_bf16 v[120:135], v[60:63], v[48:51], v[120:135]
    ds_read_b128 v[48:51], v7 offset:64
    ds_read_b64_tr_b16 v[56:57], v9 offset:10240
    ds_read_b64_tr_b16 v[58:59], v9 offset:11520
    ds_read_b64_tr_b16 v[60:61], v9 offset:10304
    ds_read_b64_tr_b16 v[62:63], v9 offset:11584
    s_waitcnt lgkmcnt(5)
    v_mfma_f32_32x32x16_bf16 v[104:119], v[64:67], v[52:55], v[104:119]
    v_mfma_f32_32x32x16_bf16 v[120:135], v[68:71], v[52:55], v[120:135]
    ds_read_b128 v[52:55], v7 offset:96
    ds_read_b64_tr_b16 v[64:65], v9 offset:15360
    ds_read_b64_tr_b16 v[66:67], v9 offset:16640
    ds_read_b64_tr_b16 v[68:69], v9 offset:15424
    ds_read_b64_tr_b16 v[70:71], v9 offset:16704
    s_waitcnt lgkmcnt(5)
    v_mfma_f32_32x32x16_bf16 v[104:119], v[56:59], v[48:51], v[104:119]
    v_mfma_f32_32x32x16_bf16 v[120:135], v[60:63], v[48:51], v[120:135]
    s_waitcnt lgkmcnt(0)
    v_mfma_f32_32x32x16_bf16 v[104:119], v[64:67], v[52:55], v[104:119]
    v_mfma_f32_32x32x16_bf16 v[120:135], v[68:71], v[52:55], v[120:135]
    s_waitcnt vmcnt(6)
    ds_write_b128 v4, v[136:139] offset:38912
    ds_write_b128 v4, v[140:143] offset:43520
    ds_write_b128 v6, v[144:147] offset:38912
    ds_write_b128 v6, v[148:151] offset:44032
    ds_write_b128 v6, v[152:155] offset:49152
    ds_write_b128 v6, v[156:159] offset:54272
    s_waitcnt lgkmcnt(0)
    s_barrier
    s_mov_b32 s90, 384
    s_mov_b32 s91, 245760
    buffer_load_dwordx4 v[136:139], v12, s[20:23], s90 offen
    buffer_load_dwordx4 v[140:143], v13, s[20:23], s90 offen
    buffer_load_dwordx4 v[144:147], v18, s[44:47], s91 offen
    buffer_load_dwordx4 v[148:151], v19, s[44:47], s91 offen
    buffer_load_dwordx4 v[152:155], v20, s[44:47], s91 offen
    buffer_load_dwordx4 v[156:159], v21, s[44:47], s91 offen
    ds_read_b128 v[48:51], v7 offset:38912
    ds_read_b64_tr_b16 v[56:57], v9 offset:38912
    ds_read_b64_tr_b16 v[58:59], v9 offset:40192
    ds_read_b64_tr_b16 v[60:61], v9 offset:38976
    ds_read_b64_tr_b16 v[62:63], v9 offset:40256
    ds_read_b128 v[52:55], v7 offset:38944
    ds_read_b64_tr_b16 v[64:65], v9 offset:44032
    ds_read_b64_tr_b16 v[66:67], v9 offset:45312
    ds_read_b64_tr_b16 v[68:69], v9 offset:44096
    ds_read_b64_tr_b16 v[70:71], v9 offset:45376
    s_waitcnt lgkmcnt(5)
    v_mfma_f32_32x32x16_bf16 v[104:119], v[56:59], v[48:51], v[104:119]
    v_mfma_f32_32x32x16_bf16 v[120:135], v[60:63], v[48:51], v[120:135]
    ds_read_b128 v[48:51], v7 offset:38976
    ds_read_b64_tr_b16 v[56:57], v9 offset:49152
    ds_read_b64_tr_b16 v[58:59], v9 offset:50432
    ds_read_b64_tr_b16 v[60:61], v9 offset:49216
    ds_read_b64_tr_b16 v[62:63], v9 offset:50496
    s_waitcnt lgkmcnt(5)
    v_mfma_f32_32x32x16_bf16 v[104:119], v[64:67], v[52:55], v[104:119]
    v_mfma_f32_32x32x16_bf16 v[120:135], v[68:71], v[52:55], v[120:135]
    ds_read_b128 v[52:55], v7 offset:39008
    ds_read_b64_tr_b16 v[64:65], v9 offset:54272
    ds_read_b64_tr_b16 v[66:67], v9 offset:55552
    ds_read_b64_tr_b16 v[68:69], v9 offset:54336
    ds_read_b64_tr_b16 v[70:71], v9 offset:55616
    s_waitcnt lgkmcnt(5)
    v_mfma_f32_32x32x16_bf16 v[104:119], v[56:59], v[48:51], v[104:119]
    v_mfma_f32_32x32x16_bf16 v[120:135], v[60:63], v[48:51], v[120:135]
    s_waitcnt lgkmcnt(0)
    v_mfma_f32_32x32x16_bf16 v[104:119], v[64:67], v[52:55], v[104:119]
    v_mfma_f32_32x32x16_bf16 v[120:135], v[68:71], v[52:55], v[120:135]
    s_waitcnt vmcnt(6)
    ds_write_b128 v4, v[24:27] offset:0
    ds_write_b128 v4, v[28:31] offset:4608
    ds_write_b128 v6, v[32:35] offset:0
    ds_write_b128 v6, v[36:39] offset:5120
    ds_write_b128 v6, v[40:43] offset:10240
    ds_write_b128 v6, v[44:47] offset:15360
    s_waitcnt lgkmcnt(0)
    s_barrier
    s_mov_b32 s90, 512
    s_mov_b32 s91, 327680
    buffer_load_dwordx4 v[24:27], v12, s[20:23], s90 offen
    buffer_load_dwordx4 v[28:31], v13, s[20:23], s90 offen
    buffer_load_dwordx4 v[32:35], v18, s[44:47], s91 offen
    buffer_load_dwordx4 v[36:39], v19, s[44:47], s91 offen
    buffer_load_dwordx4 v[40:43], v20, s[44:47], s91 offen
    buffer_load_dwordx4 v[44:47], v21, s[44:47], s91 offen
    ds_read_b128 v[48:51], v7 offset:0
    ds_read_b64_tr_b16 v[56:57], v9 offset:0
    ds_read_b64_tr_b16 v[58:59], v9 offset:1280
    ds_read_b64_tr_b16 v[60:61], v9 offset:64
    ds_read_b64_tr_b16 v[62:63], v9 offset:1344
    ds_read_b128 v[52:55], v7 offset:32
    ds_read_b64_tr_b16 v[64:65], v9 offset:5120
    ds_read_b64_tr_b16 v[66:67], v9 offset:6400
    ds_read_b64_tr_b16 v[68:69], v9 offset:5184
    ds_read_b64_tr_b16 v[70:71], v9 offset:6464
    s_waitcnt lgkmcnt(5)
    v_mfma_f32_32x32x16_bf16 v[104:119], v[56:59], v[48:51], v[104:119]
    v_mfma_f32_32x32x16_bf16 v[120:135], v[60:63], v[48:51], v[120:135]
    ds_read_b128 v[48:51], v7 offset:64
    ds_read_b64_tr_b16 v[56:57], v9 offset:10240
    ds_read_b64_tr_b16 v[58:59], v9 offset:11520
    ds_read_b64_tr_b16 v[60:61], v9 offset:10304
    ds_read_b64_tr_b16 v[62:63], v9 offset:11584
    s_waitcnt lgkmcnt(5)
    v_mfma_f32_32x32x16_bf16 v[104:119], v[64:67], v[52:55], v[104:119]
    v_mfma_f32_32x32x16_bf16 v[120:135], v[68:71], v[52:55], v[120:135]
    ds_read_b128 v[52:55], v7 offset:96
    ds_read_b64_tr_b16 v[64:65], v9 offset:15360
    ds_read_b64_tr_b16 v[66:67], v9 offset:16640
    ds_read_b64_tr_b16 v[68:69], v9 offset:15424
    ds_read_b64_tr_b16 v[70:71], v9 offset:16704
    s_waitcnt lgkmcnt(5)
    v_mfma_f32_32x32x16_bf16 v[104:119], v[56:59], v[48:51], v[104:119]
    v_mfma_f32_32x32x16_bf16 v[120:135], v[60:63], v[48:51], v[120:135]
    s_waitcnt lgkmcnt(0)
    v_mfma_f32_32x32x16_bf16 v[104:119], v[64:67], v[52:55], v[104:119]
    v_mfma_f32_32x32x16_bf16 v[120:135], v[68:71], v[52:55], v[120:135]
    s_waitcnt vmcnt(6)
    ds_write_b128 v4, v[136:139] offset:38912
    ds_write_b128 v4, v[140:143] offset:43520
    ds_write_b128 v6, v[144:147] offset:38912
    ds_write_b128 v6, v[148:151] offset:44032
    ds_write_b128 v6, v[152:155] offset:49152
    ds_write_b128 v6, v[156:159] offset:54272
    s_waitcnt lgkmcnt(0)
    s_barrier
    s_mov_b32 s90, 640
    s_mov_b32 s91, 409600
    buffer_load_dwordx4 v[136:139], v12, s[20:23], s90 offen
    buffer_load_dwordx4 v[140:143], v13, s[20:23], s90 offen
    buffer_load_dwordx4 v[144:147], v18, s[44:47], s91 offen
    buffer_load_dwordx4 v[148:151], v19, s[44:47], s91 offen
    buffer_load_dwordx4 v[152:155], v20, s[44:47], s91 offen
    buffer_load_dwordx4 v[156:159], v21, s[44:47], s91 offen
    ds_read_b128 v[48:51], v7 offset:38912
    ds_read_b64_tr_b16 v[56:57], v9 offset:38912
    ds_read_b64_tr_b16 v[58:59], v9 offset:40192
    ds_read_b64_tr_b16 v[60:61], v9 offset:38976
    ds_read_b64_tr_b16 v[62:63], v9 offset:40256
    ds_read_b128 v[52:55], v7 offset:38944
    ds_read_b64_tr_b16 v[64:65], v9 offset:44032
    ds_read_b64_tr_b16 v[66:67], v9 offset:45312
    ds_read_b64_tr_b16 v[68:69], v9 offset:44096
    ds_read_b64_tr_b16 v[70:71], v9 offset:45376
    s_waitcnt lgkmcnt(5)
    v_mfma_f32_32x32x16_bf16 v[104:119], v[56:59], v[48:51], v[104:119]
    v_mfma_f32_32x32x16_bf16 v[120:135], v[60:63], v[48:51], v[120:135]
    ds_read_b128 v[48:51], v7 offset:38976
    ds_read_b64_tr_b16 v[56:57], v9 offset:49152
    ds_read_b64_tr_b16 v[58:59], v9 offset:50432
    ds_read_b64_tr_b16 v[60:61], v9 offset:49216
    ds_read_b64_tr_b16 v[62:63], v9 offset:50496
    s_waitcnt lgkmcnt(5)
    v_mfma_f32_32x32x16_bf16 v[104:119], v[64:67], v[52:55], v[104:119]
    v_mfma_f32_32x32x16_bf16 v[120:135], v[68:71], v[52:55], v[120:135]
    ds_read_b128 v[52:55], v7 offset:39008
    ds_read_b64_tr_b16 v[64:65], v9 offset:54272
    ds_read_b64_tr_b16 v[66:67], v9 offset:55552
    ds_read_b64_tr_b16 v[68:69], v9 offset:54336
    ds_read_b64_tr_b16 v[70:71], v9 offset:55616
    s_waitcnt lgkmcnt(5)
    v_mfma_f32_32x32x16_bf16 v[104:119], v[56:59], v[48:51], v[104:119]
    v_mfma_f32_32x32x16_bf16 v[120:135], v[60:63], v[48:51], v[120:135]
    s_waitcnt lgkmcnt(0)
    v_mfma_f32_32x32x16_bf16 v[104:119], v[64:67], v[52:55], v[104:119]
    v_mfma_f32_32x32x16_bf16 v[120:135], v[68:71], v[52:55], v[120:135]
    s_waitcnt vmcnt(6)
    ds_write_b128 v4, v[24:27] offset:0
    ds_write_b128 v4, v[28:31] offset:4608
    ds_write_b128 v6, v[32:35] offset:0
    ds_write_b128 v6, v[36:39] offset:5120
    ds_write_b128 v6, v[40:43] offset:10240
    ds_write_b128 v6, v[44:47] offset:15360
    s_waitcnt lgkmcnt(0)
    s_barrier
    s_mov_b32 s90, 768
    s_mov_b32 s91, 491520
    buffer_load_dwordx4 v[24:27], v12, s[20:23], s90 offen
    buffer_load_dwordx4 v[28:31], v13, s[20:23], s90 offen
    buffer_load_dwordx4 v[32:35], v18, s[44:47], s91 offen
    buffer_load_dwordx4 v[36:39], v19, s[44:47], s91 offen
    buffer_load_dwordx4 v[40:43], v20, s[44:47], s91 offen
    buffer_load_dwordx4 v[44:47], v21, s[44:47], s91 offen
    ds_read_b128 v[48:51], v7 offset:0
    ds_read_b64_tr_b16 v[56:57], v9 offset:0
    ds_read_b64_tr_b16 v[58:59], v9 offset:1280
    ds_read_b64_tr_b16 v[60:61], v9 offset:64
    ds_read_b64_tr_b16 v[62:63], v9 offset:1344
    ds_read_b128 v[52:55], v7 offset:32
    ds_read_b64_tr_b16 v[64:65], v9 offset:5120
    ds_read_b64_tr_b16 v[66:67], v9 offset:6400
    ds_read_b64_tr_b16 v[68:69], v9 offset:5184
    ds_read_b64_tr_b16 v[70:71], v9 offset:6464
    s_waitcnt lgkmcnt(5)
    v_mfma_f32_32x32x16_bf16 v[104:119], v[56:59], v[48:51], v[104:119]
    v_mfma_f32_32x32x16_bf16 v[120:135], v[60:63], v[48:51], v[120:135]
    ds_read_b128 v[48:51], v7 offset:64
    ds_read_b64_tr_b16 v[56:57], v9 offset:10240
    ds_read_b64_tr_b16 v[58:59], v9 offset:11520
    ds_read_b64_tr_b16 v[60:61], v9 offset:10304
    ds_read_b64_tr_b16 v[62:63], v9 offset:11584
    s_waitcnt lgkmcnt(5)
    v_mfma_f32_32x32x16_bf16 v[104:119], v[64:67], v[52:55], v[104:119]
    v_mfma_f32_32x32x16_bf16 v[120:135], v[68:71], v[52:55], v[120:135]
    ds_read_b128 v[52:55], v7 offset:96
    ds_read_b64_tr_b16 v[64:65], v9 offset:15360
    ds_read_b64_tr_b16 v[66:67], v9 offset:16640
    ds_read_b64_tr_b16 v[68:69], v9 offset:15424
    ds_read_b64_tr_b16 v[70:71], v9 offset:16704
    s_waitcnt lgkmcnt(5)
    v_mfma_f32_32x32x16_bf16 v[104:119], v[56:59], v[48:51], v[104:119]
    v_mfma_f32_32x32x16_bf16 v[120:135], v[60:63], v[48:51], v[120:135]
    s_waitcnt lgkmcnt(0)
    v_mfma_f32_32x32x16_bf16 v[104:119], v[64:67], v[52:55], v[104:119]
    v_mfma_f32_32x32x16_bf16 v[120:135], v[68:71], v[52:55], v[120:135]
    s_waitcnt vmcnt(6)
    ds_write_b128 v4, v[136:139] offset:38912
    ds_write_b128 v4, v[140:143] offset:43520
    ds_write_b128 v6, v[144:147] offset:38912
    ds_write_b128 v6, v[148:151] offset:44032
    ds_write_b128 v6, v[152:155] offset:49152
    ds_write_b128 v6, v[156:159] offset:54272
    s_waitcnt lgkmcnt(0)
    s_barrier
    s_mov_b32 s90, 896
    s_mov_b32 s91, 573440
    buffer_load_dwordx4 v[136:139], v12, s[20:23], s90 offen
    buffer_load_dwordx4 v[140:143], v13, s[20:23], s90 offen
    buffer_load_dwordx4 v[144:147], v18, s[44:47], s91 offen
    buffer_load_dwordx4 v[148:151], v19, s[44:47], s91 offen
    buffer_load_dwordx4 v[152:155], v20, s[44:47], s91 offen
    buffer_load_dwordx4 v[156:159], v21, s[44:47], s91 offen
    ds_read_b128 v[48:51], v7 offset:38912
    ds_read_b64_tr_b16 v[56:57], v9 offset:38912
    ds_read_b64_tr_b16 v[58:59], v9 offset:40192
    ds_read_b64_tr_b16 v[60:61], v9 offset:38976
    ds_read_b64_tr_b16 v[62:63], v9 offset:40256
    ds_read_b128 v[52:55], v7 offset:38944
    ds_read_b64_tr_b16 v[64:65], v9 offset:44032
    ds_read_b64_tr_b16 v[66:67], v9 offset:45312
    ds_read_b64_tr_b16 v[68:69], v9 offset:44096
    ds_read_b64_tr_b16 v[70:71], v9 offset:45376
    s_waitcnt lgkmcnt(5)
    v_mfma_f32_32x32x16_bf16 v[104:119], v[56:59], v[48:51], v[104:119]
    v_mfma_f32_32x32x16_bf16 v[120:135], v[60:63], v[48:51], v[120:135]
    ds_read_b128 v[48:51], v7 offset:38976
    ds_read_b64_tr_b16 v[56:57], v9 offset:49152
    ds_read_b64_tr_b16 v[58:59], v9 offset:50432
    ds_read_b64_tr_b16 v[60:61], v9 offset:49216
    ds_read_b64_tr_b16 v[62:63], v9 offset:50496
    s_waitcnt lgkmcnt(5)
    v_mfma_f32_32x32x16_bf16 v[104:119], v[64:67], v[52:55], v[104:119]
    v_mfma_f32_32x32x16_bf16 v[120:135], v[68:71], v[52:55], v[120:135]
    ds_read_b128 v[52:55], v7 offset:39008
    ds_read_b64_tr_b16 v[64:65], v9 offset:54272
    ds_read_b64_tr_b16 v[66:67], v9 offset:55552
    ds_read_b64_tr_b16 v[68:69], v9 offset:54336
    ds_read_b64_tr_b16 v[70:71], v9 offset:55616
    s_waitcnt lgkmcnt(5)
    v_mfma_f32_32x32x16_bf16 v[104:119], v[56:59], v[48:51], v[104:119]
    v_mfma_f32_32x32x16_bf16 v[120:135], v[60:63], v[48:51], v[120:135]
    s_waitcnt lgkmcnt(0)
    v_mfma_f32_32x32x16_bf16 v[104:119], v[64:67], v[52:55], v[104:119]
    v_mfma_f32_32x32x16_bf16 v[120:135], v[68:71], v[52:55], v[120:135]
    s_waitcnt vmcnt(6)
    ds_write_b128 v4, v[24:27] offset:0
    ds_write_b128 v4, v[28:31] offset:4608
    ds_write_b128 v6, v[32:35] offset:0
    ds_write_b128 v6, v[36:39] offset:5120
    ds_write_b128 v6, v[40:43] offset:10240
    ds_write_b128 v6, v[44:47] offset:15360
    s_waitcnt lgkmcnt(0)
    s_barrier
    s_mov_b32 s90, 1024
    s_mov_b32 s91, 655360
    buffer_load_dwordx4 v[24:27], v12, s[20:23], s90 offen
    buffer_load_dwordx4 v[28:31], v13, s[20:23], s90 offen
    buffer_load_dwordx4 v[32:35], v18, s[44:47], s91 offen
    buffer_load_dwordx4 v[36:39], v19, s[44:47], s91 offen
    buffer_load_dwordx4 v[40:43], v20, s[44:47], s91 offen
    buffer_load_dwordx4 v[44:47], v21, s[44:47], s91 offen
    ds_read_b128 v[48:51], v7 offset:0
    ds_read_b64_tr_b16 v[56:57], v9 offset:0
    ds_read_b64_tr_b16 v[58:59], v9 offset:1280
    ds_read_b64_tr_b16 v[60:61], v9 offset:64
    ds_read_b64_tr_b16 v[62:63], v9 offset:1344
    ds_read_b128 v[52:55], v7 offset:32
    ds_read_b64_tr_b16 v[64:65], v9 offset:5120
    ds_read_b64_tr_b16 v[66:67], v9 offset:6400
    ds_read_b64_tr_b16 v[68:69], v9 offset:5184
    ds_read_b64_tr_b16 v[70:71], v9 offset:6464
    s_waitcnt lgkmcnt(5)
    v_mfma_f32_32x32x16_bf16 v[104:119], v[56:59], v[48:51], v[104:119]
    v_mfma_f32_32x32x16_bf16 v[120:135], v[60:63], v[48:51], v[120:135]
    ds_read_b128 v[48:51], v7 offset:64
    ds_read_b64_tr_b16 v[56:57], v9 offset:10240
    ds_read_b64_tr_b16 v[58:59], v9 offset:11520
    ds_read_b64_tr_b16 v[60:61], v9 offset:10304
    ds_read_b64_tr_b16 v[62:63], v9 offset:11584
    s_waitcnt lgkmcnt(5)
    v_mfma_f32_32x32x16_bf16 v[104:119], v[64:67], v[52:55], v[104:119]
    v_mfma_f32_32x32x16_bf16 v[120:135], v[68:71], v[52:55], v[120:135]
    ds_read_b128 v[52:55], v7 offset:96
    ds_read_b64_tr_b16 v[64:65], v9 offset:15360
    ds_read_b64_tr_b16 v[66:67], v9 offset:16640
    ds_read_b64_tr_b16 v[68:69], v9 offset:15424
    ds_read_b64_tr_b16 v[70:71], v9 offset:16704
    s_waitcnt lgkmcnt(5)
    v_mfma_f32_32x32x16_bf16 v[104:119], v[56:59], v[48:51], v[104:119]
    v_mfma_f32_32x32x16_bf16 v[120:135], v[60:63], v[48:51], v[120:135]
    s_waitcnt lgkmcnt(0)
    v_mfma_f32_32x32x16_bf16 v[104:119], v[64:67], v[52:55], v[104:119]
    v_mfma_f32_32x32x16_bf16 v[120:135], v[68:71], v[52:55], v[120:135]
    s_waitcnt vmcnt(6)
    ds_write_b128 v4, v[136:139] offset:38912
    ds_write_b128 v4, v[140:143] offset:43520
    ds_write_b128 v6, v[144:147] offset:38912
    ds_write_b128 v6, v[148:151] offset:44032
    ds_write_b128 v6, v[152:155] offset:49152
    ds_write_b128 v6, v[156:159] offset:54272
    s_waitcnt lgkmcnt(0)
    s_barrier
    s_mov_b32 s90, 1152
    s_mov_b32 s91, 737280
    buffer_load_dwordx4 v[136:139], v12, s[20:23], s90 offen
    buffer_load_dwordx4 v[140:143], v13, s[20:23], s90 offen
    buffer_load_dwordx4 v[144:147], v18, s[44:47], s91 offen
    buffer_load_dwordx4 v[148:151], v19, s[44:47], s91 offen
    buffer_load_dwordx4 v[152:155], v20, s[44:47], s91 offen
    buffer_load_dwordx4 v[156:159], v21, s[44:47], s91 offen
    ds_read_b128 v[48:51], v7 offset:38912
    ds_read_b64_tr_b16 v[56:57], v9 offset:38912
    ds_read_b64_tr_b16 v[58:59], v9 offset:40192
    ds_read_b64_tr_b16 v[60:61], v9 offset:38976
    ds_read_b64_tr_b16 v[62:63], v9 offset:40256
    ds_read_b128 v[52:55], v7 offset:38944
    ds_read_b64_tr_b16 v[64:65], v9 offset:44032
    ds_read_b64_tr_b16 v[66:67], v9 offset:45312
    ds_read_b64_tr_b16 v[68:69], v9 offset:44096
    ds_read_b64_tr_b16 v[70:71], v9 offset:45376
    s_waitcnt lgkmcnt(5)
    v_mfma_f32_32x32x16_bf16 v[104:119], v[56:59], v[48:51], v[104:119]
    v_mfma_f32_32x32x16_bf16 v[120:135], v[60:63], v[48:51], v[120:135]
    ds_read_b128 v[48:51], v7 offset:38976
    ds_read_b64_tr_b16 v[56:57], v9 offset:49152
    ds_read_b64_tr_b16 v[58:59], v9 offset:50432
    ds_read_b64_tr_b16 v[60:61], v9 offset:49216
    ds_read_b64_tr_b16 v[62:63], v9 offset:50496
    s_waitcnt lgkmcnt(5)
    v_mfma_f32_32x32x16_bf16 v[104:119], v[64:67], v[52:55], v[104:119]
    v_mfma_f32_32x32x16_bf16 v[120:135], v[68:71], v[52:55], v[120:135]
    ds_read_b128 v[52:55], v7 offset:39008
    ds_read_b64_tr_b16 v[64:65], v9 offset:54272
    ds_read_b64_tr_b16 v[66:67], v9 offset:55552
    ds_read_b64_tr_b16 v[68:69], v9 offset:54336
    ds_read_b64_tr_b16 v[70:71], v9 offset:55616
    s_waitcnt lgkmcnt(5)
    v_mfma_f32_32x32x16_bf16 v[104:119], v[56:59], v[48:51], v[104:119]
    v_mfma_f32_32x32x16_bf16 v[120:135], v[60:63], v[48:51], v[120:135]
    s_waitcnt lgkmcnt(0)
    v_mfma_f32_32x32x16_bf16 v[104:119], v[64:67], v[52:55], v[104:119]
    v_mfma_f32_32x32x16_bf16 v[120:135], v[68:71], v[52:55], v[120:135]
    s_waitcnt vmcnt(6)
    ds_write_b128 v4, v[24:27] offset:0
    ds_write_b128 v4, v[28:31] offset:4608
    ds_write_b128 v6, v[32:35] offset:0
    ds_write_b128 v6, v[36:39] offset:5120
    ds_write_b128 v6, v[40:43] offset:10240
    ds_write_b128 v6, v[44:47] offset:15360
    s_waitcnt lgkmcnt(0)
    s_barrier
    s_mov_b32 s90, 1280
    s_mov_b32 s91, 819200
    buffer_load_dwordx4 v[24:27], v12, s[20:23], s90 offen
    buffer_load_dwordx4 v[28:31], v13, s[20:23], s90 offen
    buffer_load_dwordx4 v[32:35], v18, s[44:47], s91 offen
    buffer_load_dwordx4 v[36:39], v19, s[44:47], s91 offen
    buffer_load_dwordx4 v[40:43], v20, s[44:47], s91 offen
    buffer_load_dwordx4 v[44:47], v21, s[44:47], s91 offen
    ds_read_b128 v[48:51], v7 offset:0
    ds_read_b64_tr_b16 v[56:57], v9 offset:0
    ds_read_b64_tr_b16 v[58:59], v9 offset:1280
    ds_read_b64_tr_b16 v[60:61], v9 offset:64
    ds_read_b64_tr_b16 v[62:63], v9 offset:1344
    ds_read_b128 v[52:55], v7 offset:32
    ds_read_b64_tr_b16 v[64:65], v9 offset:5120
    ds_read_b64_tr_b16 v[66:67], v9 offset:6400
    ds_read_b64_tr_b16 v[68:69], v9 offset:5184
    ds_read_b64_tr_b16 v[70:71], v9 offset:6464
    s_waitcnt lgkmcnt(5)
    v_mfma_f32_32x32x16_bf16 v[104:119], v[56:59], v[48:51], v[104:119]
    v_mfma_f32_32x32x16_bf16 v[120:135], v[60:63], v[48:51], v[120:135]
    ds_read_b128 v[48:51], v7 offset:64
    ds_read_b64_tr_b16 v[56:57], v9 offset:10240
    ds_read_b64_tr_b16 v[58:59], v9 offset:11520
    ds_read_b64_tr_b16 v[60:61], v9 offset:10304
    ds_read_b64_tr_b16 v[62:63], v9 offset:11584
    s_waitcnt lgkmcnt(5)
    v_mfma_f32_32x32x16_bf16 v[104:119], v[64:67], v[52:55], v[104:119]
    v_mfma_f32_32x32x16_bf16 v[120:135], v[68:71], v[52:55], v[120:135]
    ds_read_b128 v[52:55], v7 offset:96
    ds_read_b64_tr_b16 v[64:65], v9 offset:15360
    ds_read_b64_tr_b16 v[66:67], v9 offset:16640
    ds_read_b64_tr_b16 v[68:69], v9 offset:15424
    ds_read_b64_tr_b16 v[70:71], v9 offset:16704
    s_waitcnt lgkmcnt(5)
    v_mfma_f32_32x32x16_bf16 v[104:119], v[56:59], v[48:51], v[104:119]
    v_mfma_f32_32x32x16_bf16 v[120:135], v[60:63], v[48:51], v[120:135]
    s_waitcnt lgkmcnt(0)
    v_mfma_f32_32x32x16_bf16 v[104:119], v[64:67], v[52:55], v[104:119]
    v_mfma_f32_32x32x16_bf16 v[120:135], v[68:71], v[52:55], v[120:135]
    s_waitcnt vmcnt(6)
    ds_write_b128 v4, v[136:139] offset:38912
    ds_write_b128 v4, v[140:143] offset:43520
    ds_write_b128 v6, v[144:147] offset:38912
    ds_write_b128 v6, v[148:151] offset:44032
    ds_write_b128 v6, v[152:155] offset:49152
    ds_write_b128 v6, v[156:159] offset:54272
    s_waitcnt lgkmcnt(0)
    s_barrier
    s_mov_b32 s90, 1408
    s_mov_b32 s91, 901120
    buffer_load_dwordx4 v[136:139], v12, s[20:23], s90 offen
    buffer_load_dwordx4 v[140:143], v13, s[20:23], s90 offen
    buffer_load_dwordx4 v[144:147], v18, s[44:47], s91 offen
    buffer_load_dwordx4 v[148:151], v19, s[44:47], s91 offen
    buffer_load_dwordx4 v[152:155], v20, s[44:47], s91 offen
    buffer_load_dwordx4 v[156:159], v21, s[44:47], s91 offen
    ds_read_b128 v[48:51], v7 offset:38912
    ds_read_b64_tr_b16 v[56:57], v9 offset:38912
    ds_read_b64_tr_b16 v[58:59], v9 offset:40192
    ds_read_b64_tr_b16 v[60:61], v9 offset:38976
    ds_read_b64_tr_b16 v[62:63], v9 offset:40256
    ds_read_b128 v[52:55], v7 offset:38944
    ds_read_b64_tr_b16 v[64:65], v9 offset:44032
    ds_read_b64_tr_b16 v[66:67], v9 offset:45312
    ds_read_b64_tr_b16 v[68:69], v9 offset:44096
    ds_read_b64_tr_b16 v[70:71], v9 offset:45376
    s_waitcnt lgkmcnt(5)
    v_mfma_f32_32x32x16_bf16 v[104:119], v[56:59], v[48:51], v[104:119]
    v_mfma_f32_32x32x16_bf16 v[120:135], v[60:63], v[48:51], v[120:135]
    ds_read_b128 v[48:51], v7 offset:38976
    ds_read_b64_tr_b16 v[56:57], v9 offset:49152
    ds_read_b64_tr_b16 v[58:59], v9 offset:50432
    ds_read_b64_tr_b16 v[60:61], v9 offset:49216
    ds_read_b64_tr_b16 v[62:63], v9 offset:50496
    s_waitcnt lgkmcnt(5)
    v_mfma_f32_32x32x16_bf16 v[104:119], v[64:67], v[52:55], v[104:119]
    v_mfma_f32_32x32x16_bf16 v[120:135], v[68:71], v[52:55], v[120:135]
    ds_read_b128 v[52:55], v7 offset:39008
    ds_read_b64_tr_b16 v[64:65], v9 offset:54272
    ds_read_b64_tr_b16 v[66:67], v9 offset:55552
    ds_read_b64_tr_b16 v[68:69], v9 offset:54336
    ds_read_b64_tr_b16 v[70:71], v9 offset:55616
    s_waitcnt lgkmcnt(5)
    v_mfma_f32_32x32x16_bf16 v[104:119], v[56:59], v[48:51], v[104:119]
    v_mfma_f32_32x32x16_bf16 v[120:135], v[60:63], v[48:51], v[120:135]
    s_waitcnt lgkmcnt(0)
    v_mfma_f32_32x32x16_bf16 v[104:119], v[64:67], v[52:55], v[104:119]
    v_mfma_f32_32x32x16_bf16 v[120:135], v[68:71], v[52:55], v[120:135]
    s_waitcnt vmcnt(6)
    ds_write_b128 v4, v[24:27] offset:0
    ds_write_b128 v4, v[28:31] offset:4608
    ds_write_b128 v6, v[32:35] offset:0
    ds_write_b128 v6, v[36:39] offset:5120
    ds_write_b128 v6, v[40:43] offset:10240
    ds_write_b128 v6, v[44:47] offset:15360
    s_waitcnt lgkmcnt(0)
    s_barrier
    s_mov_b32 s90, 1536
    s_mov_b32 s91, 983040
    buffer_load_dwordx4 v[24:27], v12, s[20:23], s90 offen
    buffer_load_dwordx4 v[28:31], v13, s[20:23], s90 offen
    buffer_load_dwordx4 v[32:35], v18, s[44:47], s91 offen
    buffer_load_dwordx4 v[36:39], v19, s[44:47], s91 offen
    buffer_load_dwordx4 v[40:43], v20, s[44:47], s91 offen
    buffer_load_dwordx4 v[44:47], v21, s[44:47], s91 offen
    ds_read_b128 v[48:51], v7 offset:0
    ds_read_b64_tr_b16 v[56:57], v9 offset:0
    ds_read_b64_tr_b16 v[58:59], v9 offset:1280
    ds_read_b64_tr_b16 v[60:61], v9 offset:64
    ds_read_b64_tr_b16 v[62:63], v9 offset:1344
    ds_read_b128 v[52:55], v7 offset:32
    ds_read_b64_tr_b16 v[64:65], v9 offset:5120
    ds_read_b64_tr_b16 v[66:67], v9 offset:6400
    ds_read_b64_tr_b16 v[68:69], v9 offset:5184
    ds_read_b64_tr_b16 v[70:71], v9 offset:6464
    s_waitcnt lgkmcnt(5)
    v_mfma_f32_32x32x16_bf16 v[104:119], v[56:59], v[48:51], v[104:119]
    v_mfma_f32_32x32x16_bf16 v[120:135], v[60:63], v[48:51], v[120:135]
    ds_read_b128 v[48:51], v7 offset:64
    ds_read_b64_tr_b16 v[56:57], v9 offset:10240
    ds_read_b64_tr_b16 v[58:59], v9 offset:11520
    ds_read_b64_tr_b16 v[60:61], v9 offset:10304
    ds_read_b64_tr_b16 v[62:63], v9 offset:11584
    s_waitcnt lgkmcnt(5)
    v_mfma_f32_32x32x16_bf16 v[104:119], v[64:67], v[52:55], v[104:119]
    v_mfma_f32_32x32x16_bf16 v[120:135], v[68:71], v[52:55], v[120:135]
    ds_read_b128 v[52:55], v7 offset:96
    ds_read_b64_tr_b16 v[64:65], v9 offset:15360
    ds_read_b64_tr_b16 v[66:67], v9 offset:16640
    ds_read_b64_tr_b16 v[68:69], v9 offset:15424
    ds_read_b64_tr_b16 v[70:71], v9 offset:16704
    s_waitcnt lgkmcnt(5)
    v_mfma_f32_32x32x16_bf16 v[104:119], v[56:59], v[48:51], v[104:119]
    v_mfma_f32_32x32x16_bf16 v[120:135], v[60:63], v[48:51], v[120:135]
    s_waitcnt lgkmcnt(0)
    v_mfma_f32_32x32x16_bf16 v[104:119], v[64:67], v[52:55], v[104:119]
    v_mfma_f32_32x32x16_bf16 v[120:135], v[68:71], v[52:55], v[120:135]
    s_waitcnt vmcnt(6)
    ds_write_b128 v4, v[136:139] offset:38912
    ds_write_b128 v4, v[140:143] offset:43520
    ds_write_b128 v6, v[144:147] offset:38912
    ds_write_b128 v6, v[148:151] offset:44032
    ds_write_b128 v6, v[152:155] offset:49152
    ds_write_b128 v6, v[156:159] offset:54272
    s_waitcnt lgkmcnt(0)
    s_barrier
    s_mov_b32 s90, 1664
    s_mov_b32 s91, 1064960
    buffer_load_dwordx4 v[136:139], v12, s[20:23], s90 offen
    buffer_load_dwordx4 v[140:143], v13, s[20:23], s90 offen
    buffer_load_dwordx4 v[144:147], v18, s[44:47], s91 offen
    buffer_load_dwordx4 v[148:151], v19, s[44:47], s91 offen
    buffer_load_dwordx4 v[152:155], v20, s[44:47], s91 offen
    buffer_load_dwordx4 v[156:159], v21, s[44:47], s91 offen
    ds_read_b128 v[48:51], v7 offset:38912
    ds_read_b64_tr_b16 v[56:57], v9 offset:38912
    ds_read_b64_tr_b16 v[58:59], v9 offset:40192
    ds_read_b64_tr_b16 v[60:61], v9 offset:38976
    ds_read_b64_tr_b16 v[62:63], v9 offset:40256
    ds_read_b128 v[52:55], v7 offset:38944
    ds_read_b64_tr_b16 v[64:65], v9 offset:44032
    ds_read_b64_tr_b16 v[66:67], v9 offset:45312
    ds_read_b64_tr_b16 v[68:69], v9 offset:44096
    ds_read_b64_tr_b16 v[70:71], v9 offset:45376
    s_waitcnt lgkmcnt(5)
    v_mfma_f32_32x32x16_bf16 v[104:119], v[56:59], v[48:51], v[104:119]
    v_mfma_f32_32x32x16_bf16 v[120:135], v[60:63], v[48:51], v[120:135]
    ds_read_b128 v[48:51], v7 offset:38976
    ds_read_b64_tr_b16 v[56:57], v9 offset:49152
    ds_read_b64_tr_b16 v[58:59], v9 offset:50432
    ds_read_b64_tr_b16 v[60:61], v9 offset:49216
    ds_read_b64_tr_b16 v[62:63], v9 offset:50496
    s_waitcnt lgkmcnt(5)
    v_mfma_f32_32x32x16_bf16 v[104:119], v[64:67], v[52:55], v[104:119]
    v_mfma_f32_32x32x16_bf16 v[120:135], v[68:71], v[52:55], v[120:135]
    ds_read_b128 v[52:55], v7 offset:39008
    ds_read_b64_tr_b16 v[64:65], v9 offset:54272
    ds_read_b64_tr_b16 v[66:67], v9 offset:55552
    ds_read_b64_tr_b16 v[68:69], v9 offset:54336
    ds_read_b64_tr_b16 v[70:71], v9 offset:55616
    s_waitcnt lgkmcnt(5)
    v_mfma_f32_32x32x16_bf16 v[104:119], v[56:59], v[48:51], v[104:119]
    v_mfma_f32_32x32x16_bf16 v[120:135], v[60:63], v[48:51], v[120:135]
    s_waitcnt lgkmcnt(0)
    v_mfma_f32_32x32x16_bf16 v[104:119], v[64:67], v[52:55], v[104:119]
    v_mfma_f32_32x32x16_bf16 v[120:135], v[68:71], v[52:55], v[120:135]
    s_waitcnt vmcnt(6)
    ds_write_b128 v4, v[24:27] offset:0
    ds_write_b128 v4, v[28:31] offset:4608
    ds_write_b128 v6, v[32:35] offset:0
    ds_write_b128 v6, v[36:39] offset:5120
    ds_write_b128 v6, v[40:43] offset:10240
    ds_write_b128 v6, v[44:47] offset:15360
    s_waitcnt lgkmcnt(0)
    s_barrier
    s_mov_b32 s90, 1792
    s_mov_b32 s91, 1146880
    buffer_load_dwordx4 v[24:27], v12, s[20:23], s90 offen
    buffer_load_dwordx4 v[28:31], v13, s[20:23], s90 offen
    buffer_load_dwordx4 v[32:35], v18, s[44:47], s91 offen
    buffer_load_dwordx4 v[36:39], v19, s[44:47], s91 offen
    buffer_load_dwordx4 v[40:43], v20, s[44:47], s91 offen
    buffer_load_dwordx4 v[44:47], v21, s[44:47], s91 offen
    ds_read_b128 v[48:51], v7 offset:0
    ds_read_b64_tr_b16 v[56:57], v9 offset:0
    ds_read_b64_tr_b16 v[58:59], v9 offset:1280
    ds_read_b64_tr_b16 v[60:61], v9 offset:64
    ds_read_b64_tr_b16 v[62:63], v9 offset:1344
    ds_read_b128 v[52:55], v7 offset:32
    ds_read_b64_tr_b16 v[64:65], v9 offset:5120
    ds_read_b64_tr_b16 v[66:67], v9 offset:6400
    ds_read_b64_tr_b16 v[68:69], v9 offset:5184
    ds_read_b64_tr_b16 v[70:71], v9 offset:6464
    s_waitcnt lgkmcnt(5)
    v_mfma_f32_32x32x16_bf16 v[104:119], v[56:59], v[48:51], v[104:119]
    v_mfma_f32_32x32x16_bf16 v[120:135], v[60:63], v[48:51], v[120:135]
    ds_read_b128 v[48:51], v7 offset:64
    ds_read_b64_tr_b16 v[56:57], v9 offset:10240
    ds_read_b64_tr_b16 v[58:59], v9 offset:11520
    ds_read_b64_tr_b16 v[60:61], v9 offset:10304
    ds_read_b64_tr_b16 v[62:63], v9 offset:11584
    s_waitcnt lgkmcnt(5)
    v_mfma_f32_32x32x16_bf16 v[104:119], v[64:67], v[52:55], v[104:119]
    v_mfma_f32_32x32x16_bf16 v[120:135], v[68:71], v[52:55], v[120:135]
    ds_read_b128 v[52:55], v7 offset:96
    ds_read_b64_tr_b16 v[64:65], v9 offset:15360
    ds_read_b64_tr_b16 v[66:67], v9 offset:16640
    ds_read_b64_tr_b16 v[68:69], v9 offset:15424
    ds_read_b64_tr_b16 v[70:71], v9 offset:16704
    s_waitcnt lgkmcnt(5)
    v_mfma_f32_32x32x16_bf16 v[104:119], v[56:59], v[48:51], v[104:119]
    v_mfma_f32_32x32x16_bf16 v[120:135], v[60:63], v[48:51], v[120:135]
    s_waitcnt lgkmcnt(0)
    v_mfma_f32_32x32x16_bf16 v[104:119], v[64:67], v[52:55], v[104:119]
    v_mfma_f32_32x32x16_bf16 v[120:135], v[68:71], v[52:55], v[120:135]
    s_waitcnt vmcnt(6)
    ds_write_b128 v4, v[136:139] offset:38912
    ds_write_b128 v4, v[140:143] offset:43520
    ds_write_b128 v6, v[144:147] offset:38912
    ds_write_b128 v6, v[148:151] offset:44032
    ds_write_b128 v6, v[152:155] offset:49152
    ds_write_b128 v6, v[156:159] offset:54272
    s_waitcnt lgkmcnt(0)
    s_barrier
    s_mov_b32 s90, 1920
    s_mov_b32 s91, 1228800
    buffer_load_dwordx4 v[136:139], v12, s[20:23], s90 offen
    buffer_load_dwordx4 v[140:143], v13, s[20:23], s90 offen
    buffer_load_dwordx4 v[144:147], v18, s[44:47], s91 offen
    buffer_load_dwordx4 v[148:151], v19, s[44:47], s91 offen
    buffer_load_dwordx4 v[152:155], v20, s[44:47], s91 offen
    buffer_load_dwordx4 v[156:159], v21, s[44:47], s91 offen
    ds_read_b128 v[48:51], v7 offset:38912
    ds_read_b64_tr_b16 v[56:57], v9 offset:38912
    ds_read_b64_tr_b16 v[58:59], v9 offset:40192
    ds_read_b64_tr_b16 v[60:61], v9 offset:38976
    ds_read_b64_tr_b16 v[62:63], v9 offset:40256
    ds_read_b128 v[52:55], v7 offset:38944
    ds_read_b64_tr_b16 v[64:65], v9 offset:44032
    ds_read_b64_tr_b16 v[66:67], v9 offset:45312
    ds_read_b64_tr_b16 v[68:69], v9 offset:44096
    ds_read_b64_tr_b16 v[70:71], v9 offset:45376
    s_waitcnt lgkmcnt(5)
    v_mfma_f32_32x32x16_bf16 v[104:119], v[56:59], v[48:51], v[104:119]
    v_mfma_f32_32x32x16_bf16 v[120:135], v[60:63], v[48:51], v[120:135]
    ds_read_b128 v[48:51], v7 offset:38976
    ds_read_b64_tr_b16 v[56:57], v9 offset:49152
    ds_read_b64_tr_b16 v[58:59], v9 offset:50432
    ds_read_b64_tr_b16 v[60:61], v9 offset:49216
    ds_read_b64_tr_b16 v[62:63], v9 offset:50496
    s_waitcnt lgkmcnt(5)
    v_mfma_f32_32x32x16_bf16 v[104:119], v[64:67], v[52:55], v[104:119]
    v_mfma_f32_32x32x16_bf16 v[120:135], v[68:71], v[52:55], v[120:135]
    ds_read_b128 v[52:55], v7 offset:39008
    ds_read_b64_tr_b16 v[64:65], v9 offset:54272
    ds_read_b64_tr_b16 v[66:67], v9 offset:55552
    ds_read_b64_tr_b16 v[68:69], v9 offset:54336
    ds_read_b64_tr_b16 v[70:71], v9 offset:55616
    s_waitcnt lgkmcnt(5)
    v_mfma_f32_32x32x16_bf16 v[104:119], v[56:59], v[48:51], v[104:119]
    v_mfma_f32_32x32x16_bf16 v[120:135], v[60:63], v[48:51], v[120:135]
    s_waitcnt lgkmcnt(0)
    v_mfma_f32_32x32x16_bf16 v[104:119], v[64:67], v[52:55], v[104:119]
    v_mfma_f32_32x32x16_bf16 v[120:135], v[68:71], v[52:55], v[120:135]
    s_waitcnt vmcnt(6)
    ds_write_b128 v4, v[24:27] offset:0
    ds_write_b128 v4, v[28:31] offset:4608
    ds_write_b128 v6, v[32:35] offset:0
    ds_write_b128 v6, v[36:39] offset:5120
    ds_write_b128 v6, v[40:43] offset:10240
    ds_write_b128 v6, v[44:47] offset:15360
    s_waitcnt lgkmcnt(0)
    s_barrier
    s_mov_b32 s90, 2048
    s_mov_b32 s91, 1310720
    buffer_load_dwordx4 v[24:27], v12, s[20:23], s90 offen
    buffer_load_dwordx4 v[28:31], v13, s[20:23], s90 offen
    buffer_load_dwordx4 v[32:35], v18, s[44:47], s91 offen
    buffer_load_dwordx4 v[36:39], v19, s[44:47], s91 offen
    buffer_load_dwordx4 v[40:43], v20, s[44:47], s91 offen
    buffer_load_dwordx4 v[44:47], v21, s[44:47], s91 offen
    ds_read_b128 v[48:51], v7 offset:0
    ds_read_b64_tr_b16 v[56:57], v9 offset:0
    ds_read_b64_tr_b16 v[58:59], v9 offset:1280
    ds_read_b64_tr_b16 v[60:61], v9 offset:64
    ds_read_b64_tr_b16 v[62:63], v9 offset:1344
    ds_read_b128 v[52:55], v7 offset:32
    ds_read_b64_tr_b16 v[64:65], v9 offset:5120
    ds_read_b64_tr_b16 v[66:67], v9 offset:6400
    ds_read_b64_tr_b16 v[68:69], v9 offset:5184
    ds_read_b64_tr_b16 v[70:71], v9 offset:6464
    s_waitcnt lgkmcnt(5)
    v_mfma_f32_32x32x16_bf16 v[104:119], v[56:59], v[48:51], v[104:119]
    v_mfma_f32_32x32x16_bf16 v[120:135], v[60:63], v[48:51], v[120:135]
    ds_read_b128 v[48:51], v7 offset:64
    ds_read_b64_tr_b16 v[56:57], v9 offset:10240
    ds_read_b64_tr_b16 v[58:59], v9 offset:11520
    ds_read_b64_tr_b16 v[60:61], v9 offset:10304
    ds_read_b64_tr_b16 v[62:63], v9 offset:11584
    s_waitcnt lgkmcnt(5)
    v_mfma_f32_32x32x16_bf16 v[104:119], v[64:67], v[52:55], v[104:119]
    v_mfma_f32_32x32x16_bf16 v[120:135], v[68:71], v[52:55], v[120:135]
    ds_read_b128 v[52:55], v7 offset:96
    ds_read_b64_tr_b16 v[64:65], v9 offset:15360
    ds_read_b64_tr_b16 v[66:67], v9 offset:16640
    ds_read_b64_tr_b16 v[68:69], v9 offset:15424
    ds_read_b64_tr_b16 v[70:71], v9 offset:16704
    s_waitcnt lgkmcnt(5)
    v_mfma_f32_32x32x16_bf16 v[104:119], v[56:59], v[48:51], v[104:119]
    v_mfma_f32_32x32x16_bf16 v[120:135], v[60:63], v[48:51], v[120:135]
    s_waitcnt lgkmcnt(0)
    v_mfma_f32_32x32x16_bf16 v[104:119], v[64:67], v[52:55], v[104:119]
    v_mfma_f32_32x32x16_bf16 v[120:135], v[68:71], v[52:55], v[120:135]
    s_waitcnt vmcnt(6)
    ds_write_b128 v4, v[136:139] offset:38912
    ds_write_b128 v4, v[140:143] offset:43520
    ds_write_b128 v6, v[144:147] offset:38912
    ds_write_b128 v6, v[148:151] offset:44032
    ds_write_b128 v6, v[152:155] offset:49152
    ds_write_b128 v6, v[156:159] offset:54272
    s_waitcnt lgkmcnt(0)
    s_barrier
    s_mov_b32 s90, 2176
    s_mov_b32 s91, 1392640
    buffer_load_dwordx4 v[136:139], v12, s[20:23], s90 offen
    buffer_load_dwordx4 v[140:143], v13, s[20:23], s90 offen
    buffer_load_dwordx4 v[144:147], v18, s[44:47], s91 offen
    buffer_load_dwordx4 v[148:151], v19, s[44:47], s91 offen
    buffer_load_dwordx4 v[152:155], v20, s[44:47], s91 offen
    buffer_load_dwordx4 v[156:159], v21, s[44:47], s91 offen
    ds_read_b128 v[48:51], v7 offset:38912
    ds_read_b64_tr_b16 v[56:57], v9 offset:38912
    ds_read_b64_tr_b16 v[58:59], v9 offset:40192
    ds_read_b64_tr_b16 v[60:61], v9 offset:38976
    ds_read_b64_tr_b16 v[62:63], v9 offset:40256
    ds_read_b128 v[52:55], v7 offset:38944
    ds_read_b64_tr_b16 v[64:65], v9 offset:44032
    ds_read_b64_tr_b16 v[66:67], v9 offset:45312
    ds_read_b64_tr_b16 v[68:69], v9 offset:44096
    ds_read_b64_tr_b16 v[70:71], v9 offset:45376
    s_waitcnt lgkmcnt(5)
    v_mfma_f32_32x32x16_bf16 v[104:119], v[56:59], v[48:51], v[104:119]
    v_mfma_f32_32x32x16_bf16 v[120:135], v[60:63], v[48:51], v[120:135]
    ds_read_b128 v[48:51], v7 offset:38976
    ds_read_b64_tr_b16 v[56:57], v9 offset:49152
    ds_read_b64_tr_b16 v[58:59], v9 offset:50432
    ds_read_b64_tr_b16 v[60:61], v9 offset:49216
    ds_read_b64_tr_b16 v[62:63], v9 offset:50496
    s_waitcnt lgkmcnt(5)
    v_mfma_f32_32x32x16_bf16 v[104:119], v[64:67], v[52:55], v[104:119]
    v_mfma_f32_32x32x16_bf16 v[120:135], v[68:71], v[52:55], v[120:135]
    ds_read_b128 v[52:55], v7 offset:39008
    ds_read_b64_tr_b16 v[64:65], v9 offset:54272
    ds_read_b64_tr_b16 v[66:67], v9 offset:55552
    ds_read_b64_tr_b16 v[68:69], v9 offset:54336
    ds_read_b64_tr_b16 v[70:71], v9 offset:55616
    s_waitcnt lgkmcnt(5)
    v_mfma_f32_32x32x16_bf16 v[104:119], v[56:59], v[48:51], v[104:119]
    v_mfma_f32_32x32x16_bf16 v[120:135], v[60:63], v[48:51], v[120:135]
    s_waitcnt lgkmcnt(0)
    v_mfma_f32_32x32x16_bf16 v[104:119], v[64:67], v[52:55], v[104:119]
    v_mfma_f32_32x32x16_bf16 v[120:135], v[68:71], v[52:55], v[120:135]
    s_waitcnt vmcnt(6)
    ds_write_b128 v4, v[24:27] offset:0
    ds_write_b128 v4, v[28:31] offset:4608
    ds_write_b128 v6, v[32:35] offset:0
    ds_write_b128 v6, v[36:39] offset:5120
    ds_write_b128 v6, v[40:43] offset:10240
    ds_write_b128 v6, v[44:47] offset:15360
    s_waitcnt lgkmcnt(0)
    s_barrier
    s_mov_b32 s90, 2304
    s_mov_b32 s91, 1474560
    buffer_load_dwordx4 v[24:27], v12, s[20:23], s90 offen
    buffer_load_dwordx4 v[28:31], v13, s[20:23], s90 offen
    buffer_load_dwordx4 v[32:35], v18, s[44:47], s91 offen
    buffer_load_dwordx4 v[36:39], v19, s[44:47], s91 offen
    buffer_load_dwordx4 v[40:43], v20, s[44:47], s91 offen
    buffer_load_dwordx4 v[44:47], v21, s[44:47], s91 offen
    ds_read_b128 v[48:51], v7 offset:0
    ds_read_b64_tr_b16 v[56:57], v9 offset:0
    ds_read_b64_tr_b16 v[58:59], v9 offset:1280
    ds_read_b64_tr_b16 v[60:61], v9 offset:64
    ds_read_b64_tr_b16 v[62:63], v9 offset:1344
    ds_read_b128 v[52:55], v7 offset:32
    ds_read_b64_tr_b16 v[64:65], v9 offset:5120
    ds_read_b64_tr_b16 v[66:67], v9 offset:6400
    ds_read_b64_tr_b16 v[68:69], v9 offset:5184
    ds_read_b64_tr_b16 v[70:71], v9 offset:6464
    s_waitcnt lgkmcnt(5)
    v_mfma_f32_32x32x16_bf16 v[104:119], v[56:59], v[48:51], v[104:119]
    v_mfma_f32_32x32x16_bf16 v[120:135], v[60:63], v[48:51], v[120:135]
    ds_read_b128 v[48:51], v7 offset:64
    ds_read_b64_tr_b16 v[56:57], v9 offset:10240
    ds_read_b64_tr_b16 v[58:59], v9 offset:11520
    ds_read_b64_tr_b16 v[60:61], v9 offset:10304
    ds_read_b64_tr_b16 v[62:63], v9 offset:11584
    s_waitcnt lgkmcnt(5)
    v_mfma_f32_32x32x16_bf16 v[104:119], v[64:67], v[52:55], v[104:119]
    v_mfma_f32_32x32x16_bf16 v[120:135], v[68:71], v[52:55], v[120:135]
    ds_read_b128 v[52:55], v7 offset:96
    ds_read_b64_tr_b16 v[64:65], v9 offset:15360
    ds_read_b64_tr_b16 v[66:67], v9 offset:16640
    ds_read_b64_tr_b16 v[68:69], v9 offset:15424
    ds_read_b64_tr_b16 v[70:71], v9 offset:16704
    s_waitcnt lgkmcnt(5)
    v_mfma_f32_32x32x16_bf16 v[104:119], v[56:59], v[48:51], v[104:119]
    v_mfma_f32_32x32x16_bf16 v[120:135], v[60:63], v[48:51], v[120:135]
    s_waitcnt lgkmcnt(0)
    v_mfma_f32_32x32x16_bf16 v[104:119], v[64:67], v[52:55], v[104:119]
    v_mfma_f32_32x32x16_bf16 v[120:135], v[68:71], v[52:55], v[120:135]
    s_waitcnt vmcnt(6)
    ds_write_b128 v4, v[136:139] offset:38912
    ds_write_b128 v4, v[140:143] offset:43520
    ds_write_b128 v6, v[144:147] offset:38912
    ds_write_b128 v6, v[148:151] offset:44032
    ds_write_b128 v6, v[152:155] offset:49152
    ds_write_b128 v6, v[156:159] offset:54272
    s_waitcnt lgkmcnt(0)
    s_barrier
    s_mov_b32 s90, 2432
    s_mov_b32 s91, 1556480
    buffer_load_dwordx4 v[136:139], v12, s[20:23], s90 offen
    buffer_load_dwordx4 v[140:143], v13, s[20:23], s90 offen
    buffer_load_dwordx4 v[144:147], v18, s[44:47], s91 offen
    buffer_load_dwordx4 v[148:151], v19, s[44:47], s91 offen
    buffer_load_dwordx4 v[152:155], v20, s[44:47], s91 offen
    buffer_load_dwordx4 v[156:159], v21, s[44:47], s91 offen
    ds_read_b128 v[48:51], v7 offset:38912
    ds_read_b64_tr_b16 v[56:57], v9 offset:38912
    ds_read_b64_tr_b16 v[58:59], v9 offset:40192
    ds_read_b64_tr_b16 v[60:61], v9 offset:38976
    ds_read_b64_tr_b16 v[62:63], v9 offset:40256
    ds_read_b128 v[52:55], v7 offset:38944
    ds_read_b64_tr_b16 v[64:65], v9 offset:44032
    ds_read_b64_tr_b16 v[66:67], v9 offset:45312
    ds_read_b64_tr_b16 v[68:69], v9 offset:44096
    ds_read_b64_tr_b16 v[70:71], v9 offset:45376
    s_waitcnt lgkmcnt(5)
    v_mfma_f32_32x32x16_bf16 v[104:119], v[56:59], v[48:51], v[104:119]
    v_mfma_f32_32x32x16_bf16 v[120:135], v[60:63], v[48:51], v[120:135]
    ds_read_b128 v[48:51], v7 offset:38976
    ds_read_b64_tr_b16 v[56:57], v9 offset:49152
    ds_read_b64_tr_b16 v[58:59], v9 offset:50432
    ds_read_b64_tr_b16 v[60:61], v9 offset:49216
    ds_read_b64_tr_b16 v[62:63], v9 offset:50496
    s_waitcnt lgkmcnt(5)
    v_mfma_f32_32x32x16_bf16 v[104:119], v[64:67], v[52:55], v[104:119]
    v_mfma_f32_32x32x16_bf16 v[120:135], v[68:71], v[52:55], v[120:135]
    ds_read_b128 v[52:55], v7 offset:39008
    ds_read_b64_tr_b16 v[64:65], v9 offset:54272
    ds_read_b64_tr_b16 v[66:67], v9 offset:55552
    ds_read_b64_tr_b16 v[68:69], v9 offset:54336
    ds_read_b64_tr_b16 v[70:71], v9 offset:55616
    s_waitcnt lgkmcnt(5)
    v_mfma_f32_32x32x16_bf16 v[104:119], v[56:59], v[48:51], v[104:119]
    v_mfma_f32_32x32x16_bf16 v[120:135], v[60:63], v[48:51], v[120:135]
    s_waitcnt lgkmcnt(0)
    v_mfma_f32_32x32x16_bf16 v[104:119], v[64:67], v[52:55], v[104:119]
    v_mfma_f32_32x32x16_bf16 v[120:135], v[68:71], v[52:55], v[120:135]
    s_waitcnt vmcnt(6)
    ds_write_b128 v4, v[24:27] offset:0
    ds_write_b128 v4, v[28:31] offset:4608
    ds_write_b128 v6, v[32:35] offset:0
    ds_write_b128 v6, v[36:39] offset:5120
    ds_write_b128 v6, v[40:43] offset:10240
    ds_write_b128 v6, v[44:47] offset:15360
    s_waitcnt lgkmcnt(0)
    s_barrier
    s_mov_b32 s90, 2560
    s_mov_b32 s91, 1638400
    buffer_load_dwordx4 v[24:27], v12, s[20:23], s90 offen
    buffer_load_dwordx4 v[28:31], v13, s[20:23], s90 offen
    buffer_load_dwordx4 v[32:35], v18, s[44:47], s91 offen
    buffer_load_dwordx4 v[36:39], v19, s[44:47], s91 offen
    buffer_load_dwordx4 v[40:43], v20, s[44:47], s91 offen
    buffer_load_dwordx4 v[44:47], v21, s[44:47], s91 offen
    ds_read_b128 v[48:51], v7 offset:0
    ds_read_b64_tr_b16 v[56:57], v9 offset:0
    ds_read_b64_tr_b16 v[58:59], v9 offset:1280
    ds_read_b64_tr_b16 v[60:61], v9 offset:64
    ds_read_b64_tr_b16 v[62:63], v9 offset:1344
    ds_read_b128 v[52:55], v7 offset:32
    ds_read_b64_tr_b16 v[64:65], v9 offset:5120
    ds_read_b64_tr_b16 v[66:67], v9 offset:6400
    ds_read_b64_tr_b16 v[68:69], v9 offset:5184
    ds_read_b64_tr_b16 v[70:71], v9 offset:6464
    s_waitcnt lgkmcnt(5)
    v_mfma_f32_32x32x16_bf16 v[104:119], v[56:59], v[48:51], v[104:119]
    v_mfma_f32_32x32x16_bf16 v[120:135], v[60:63], v[48:51], v[120:135]
    ds_read_b128 v[48:51], v7 offset:64
    ds_read_b64_tr_b16 v[56:57], v9 offset:10240
    ds_read_b64_tr_b16 v[58:59], v9 offset:11520
    ds_read_b64_tr_b16 v[60:61], v9 offset:10304
    ds_read_b64_tr_b16 v[62:63], v9 offset:11584
    s_waitcnt lgkmcnt(5)
    v_mfma_f32_32x32x16_bf16 v[104:119], v[64:67], v[52:55], v[104:119]
    v_mfma_f32_32x32x16_bf16 v[120:135], v[68:71], v[52:55], v[120:135]
    ds_read_b128 v[52:55], v7 offset:96
    ds_read_b64_tr_b16 v[64:65], v9 offset:15360
    ds_read_b64_tr_b16 v[66:67], v9 offset:16640
    ds_read_b64_tr_b16 v[68:69], v9 offset:15424
    ds_read_b64_tr_b16 v[70:71], v9 offset:16704
    s_waitcnt lgkmcnt(5)
    v_mfma_f32_32x32x16_bf16 v[104:119], v[56:59], v[48:51], v[104:119]
    v_mfma_f32_32x32x16_bf16 v[120:135], v[60:63], v[48:51], v[120:135]
    s_waitcnt lgkmcnt(0)
    v_mfma_f32_32x32x16_bf16 v[104:119], v[64:67], v[52:55], v[104:119]
    v_mfma_f32_32x32x16_bf16 v[120:135], v[68:71], v[52:55], v[120:135]
    s_waitcnt vmcnt(6)
    ds_write_b128 v4, v[136:139] offset:38912
    ds_write_b128 v4, v[140:143] offset:43520
    ds_write_b128 v6, v[144:147] offset:38912
    ds_write_b128 v6, v[148:151] offset:44032
    ds_write_b128 v6, v[152:155] offset:49152
    ds_write_b128 v6, v[156:159] offset:54272
    s_waitcnt lgkmcnt(0)
    s_barrier
    s_mov_b32 s90, 2688
    s_mov_b32 s91, 1720320
    buffer_load_dwordx4 v[136:139], v12, s[20:23], s90 offen
    buffer_load_dwordx4 v[140:143], v13, s[20:23], s90 offen
    buffer_load_dwordx4 v[144:147], v18, s[44:47], s91 offen
    buffer_load_dwordx4 v[148:151], v19, s[44:47], s91 offen
    buffer_load_dwordx4 v[152:155], v20, s[44:47], s91 offen
    buffer_load_dwordx4 v[156:159], v21, s[44:47], s91 offen
    ds_read_b128 v[48:51], v7 offset:38912
    ds_read_b64_tr_b16 v[56:57], v9 offset:38912
    ds_read_b64_tr_b16 v[58:59], v9 offset:40192
    ds_read_b64_tr_b16 v[60:61], v9 offset:38976
    ds_read_b64_tr_b16 v[62:63], v9 offset:40256
    ds_read_b128 v[52:55], v7 offset:38944
    ds_read_b64_tr_b16 v[64:65], v9 offset:44032
    ds_read_b64_tr_b16 v[66:67], v9 offset:45312
    ds_read_b64_tr_b16 v[68:69], v9 offset:44096
    ds_read_b64_tr_b16 v[70:71], v9 offset:45376
    s_waitcnt lgkmcnt(5)
    v_mfma_f32_32x32x16_bf16 v[104:119], v[56:59], v[48:51], v[104:119]
    v_mfma_f32_32x32x16_bf16 v[120:135], v[60:63], v[48:51], v[120:135]
    ds_read_b128 v[48:51], v7 offset:38976
    ds_read_b64_tr_b16 v[56:57], v9 offset:49152
    ds_read_b64_tr_b16 v[58:59], v9 offset:50432
    ds_read_b64_tr_b16 v[60:61], v9 offset:49216
    ds_read_b64_tr_b16 v[62:63], v9 offset:50496
    s_waitcnt lgkmcnt(5)
    v_mfma_f32_32x32x16_bf16 v[104:119], v[64:67], v[52:55], v[104:119]
    v_mfma_f32_32x32x16_bf16 v[120:135], v[68:71], v[52:55], v[120:135]
    ds_read_b128 v[52:55], v7 offset:39008
    ds_read_b64_tr_b16 v[64:65], v9 offset:54272
    ds_read_b64_tr_b16 v[66:67], v9 offset:55552
    ds_read_b64_tr_b16 v[68:69], v9 offset:54336
    ds_read_b64_tr_b16 v[70:71], v9 offset:55616
    s_waitcnt lgkmcnt(5)
    v_mfma_f32_32x32x16_bf16 v[104:119], v[56:59], v[48:51], v[104:119]
    v_mfma_f32_32x32x16_bf16 v[120:135], v[60:63], v[48:51], v[120:135]
    s_waitcnt lgkmcnt(0)
    v_mfma_f32_32x32x16_bf16 v[104:119], v[64:67], v[52:55], v[104:119]
    v_mfma_f32_32x32x16_bf16 v[120:135], v[68:71], v[52:55], v[120:135]
    s_waitcnt vmcnt(6)
    ds_write_b128 v4, v[24:27] offset:0
    ds_write_b128 v4, v[28:31] offset:4608
    ds_write_b128 v6, v[32:35] offset:0
    ds_write_b128 v6, v[36:39] offset:5120
    ds_write_b128 v6, v[40:43] offset:10240
    ds_write_b128 v6, v[44:47] offset:15360
    s_waitcnt lgkmcnt(0)
    s_barrier
    s_mov_b32 s90, 2816
    s_mov_b32 s91, 1802240
    buffer_load_dwordx4 v[24:27], v12, s[20:23], s90 offen
    buffer_load_dwordx4 v[28:31], v13, s[20:23], s90 offen
    buffer_load_dwordx4 v[32:35], v18, s[44:47], s91 offen
    buffer_load_dwordx4 v[36:39], v19, s[44:47], s91 offen
    buffer_load_dwordx4 v[40:43], v20, s[44:47], s91 offen
    buffer_load_dwordx4 v[44:47], v21, s[44:47], s91 offen
    ds_read_b128 v[48:51], v7 offset:0
    ds_read_b64_tr_b16 v[56:57], v9 offset:0
    ds_read_b64_tr_b16 v[58:59], v9 offset:1280
    ds_read_b64_tr_b16 v[60:61], v9 offset:64
    ds_read_b64_tr_b16 v[62:63], v9 offset:1344
    ds_read_b128 v[52:55], v7 offset:32
    ds_read_b64_tr_b16 v[64:65], v9 offset:5120
    ds_read_b64_tr_b16 v[66:67], v9 offset:6400
    ds_read_b64_tr_b16 v[68:69], v9 offset:5184
    ds_read_b64_tr_b16 v[70:71], v9 offset:6464
    s_waitcnt lgkmcnt(5)
    v_mfma_f32_32x32x16_bf16 v[104:119], v[56:59], v[48:51], v[104:119]
    v_mfma_f32_32x32x16_bf16 v[120:135], v[60:63], v[48:51], v[120:135]
    ds_read_b128 v[48:51], v7 offset:64
    ds_read_b64_tr_b16 v[56:57], v9 offset:10240
    ds_read_b64_tr_b16 v[58:59], v9 offset:11520
    ds_read_b64_tr_b16 v[60:61], v9 offset:10304
    ds_read_b64_tr_b16 v[62:63], v9 offset:11584
    s_waitcnt lgkmcnt(5)
    v_mfma_f32_32x32x16_bf16 v[104:119], v[64:67], v[52:55], v[104:119]
    v_mfma_f32_32x32x16_bf16 v[120:135], v[68:71], v[52:55], v[120:135]
    ds_read_b128 v[52:55], v7 offset:96
    ds_read_b64_tr_b16 v[64:65], v9 offset:15360
    ds_read_b64_tr_b16 v[66:67], v9 offset:16640
    ds_read_b64_tr_b16 v[68:69], v9 offset:15424
    ds_read_b64_tr_b16 v[70:71], v9 offset:16704
    s_waitcnt lgkmcnt(5)
    v_mfma_f32_32x32x16_bf16 v[104:119], v[56:59], v[48:51], v[104:119]
    v_mfma_f32_32x32x16_bf16 v[120:135], v[60:63], v[48:51], v[120:135]
    s_waitcnt lgkmcnt(0)
    v_mfma_f32_32x32x16_bf16 v[104:119], v[64:67], v[52:55], v[104:119]
    v_mfma_f32_32x32x16_bf16 v[120:135], v[68:71], v[52:55], v[120:135]
    s_waitcnt vmcnt(6)
    ds_write_b128 v4, v[136:139] offset:38912
    ds_write_b128 v4, v[140:143] offset:43520
    ds_write_b128 v6, v[144:147] offset:38912
    ds_write_b128 v6, v[148:151] offset:44032
    ds_write_b128 v6, v[152:155] offset:49152
    ds_write_b128 v6, v[156:159] offset:54272
    s_waitcnt lgkmcnt(0)
    s_barrier
    s_mov_b32 s90, 2944
    s_mov_b32 s91, 1884160
    buffer_load_dwordx4 v[136:139], v12, s[20:23], s90 offen
    buffer_load_dwordx4 v[140:143], v13, s[20:23], s90 offen
    buffer_load_dwordx4 v[144:147], v18, s[44:47], s91 offen
    buffer_load_dwordx4 v[148:151], v19, s[44:47], s91 offen
    buffer_load_dwordx4 v[152:155], v20, s[44:47], s91 offen
    buffer_load_dwordx4 v[156:159], v21, s[44:47], s91 offen
    ds_read_b128 v[48:51], v7 offset:38912
    ds_read_b64_tr_b16 v[56:57], v9 offset:38912
    ds_read_b64_tr_b16 v[58:59], v9 offset:40192
    ds_read_b64_tr_b16 v[60:61], v9 offset:38976
    ds_read_b64_tr_b16 v[62:63], v9 offset:40256
    ds_read_b128 v[52:55], v7 offset:38944
    ds_read_b64_tr_b16 v[64:65], v9 offset:44032
    ds_read_b64_tr_b16 v[66:67], v9 offset:45312
    ds_read_b64_tr_b16 v[68:69], v9 offset:44096
    ds_read_b64_tr_b16 v[70:71], v9 offset:45376
    s_waitcnt lgkmcnt(5)
    v_mfma_f32_32x32x16_bf16 v[104:119], v[56:59], v[48:51], v[104:119]
    v_mfma_f32_32x32x16_bf16 v[120:135], v[60:63], v[48:51], v[120:135]
    ds_read_b128 v[48:51], v7 offset:38976
    ds_read_b64_tr_b16 v[56:57], v9 offset:49152
    ds_read_b64_tr_b16 v[58:59], v9 offset:50432
    ds_read_b64_tr_b16 v[60:61], v9 offset:49216
    ds_read_b64_tr_b16 v[62:63], v9 offset:50496
    s_waitcnt lgkmcnt(5)
    v_mfma_f32_32x32x16_bf16 v[104:119], v[64:67], v[52:55], v[104:119]
    v_mfma_f32_32x32x16_bf16 v[120:135], v[68:71], v[52:55], v[120:135]
    ds_read_b128 v[52:55], v7 offset:39008
    ds_read_b64_tr_b16 v[64:65], v9 offset:54272
    ds_read_b64_tr_b16 v[66:67], v9 offset:55552
    ds_read_b64_tr_b16 v[68:69], v9 offset:54336
    ds_read_b64_tr_b16 v[70:71], v9 offset:55616
    s_waitcnt lgkmcnt(5)
    v_mfma_f32_32x32x16_bf16 v[104:119], v[56:59], v[48:51], v[104:119]
    v_mfma_f32_32x32x16_bf16 v[120:135], v[60:63], v[48:51], v[120:135]
    s_waitcnt lgkmcnt(0)
    v_mfma_f32_32x32x16_bf16 v[104:119], v[64:67], v[52:55], v[104:119]
    v_mfma_f32_32x32x16_bf16 v[120:135], v[68:71], v[52:55], v[120:135]
    s_waitcnt vmcnt(6)
    ds_write_b128 v4, v[24:27] offset:0
    ds_write_b128 v4, v[28:31] offset:4608
    ds_write_b128 v6, v[32:35] offset:0
    ds_write_b128 v6, v[36:39] offset:5120
    ds_write_b128 v6, v[40:43] offset:10240
    ds_write_b128 v6, v[44:47] offset:15360
    s_waitcnt lgkmcnt(0)
    s_barrier
    s_mov_b32 s90, 3072
    s_mov_b32 s91, 1966080
    buffer_load_dwordx4 v[24:27], v12, s[20:23], s90 offen
    buffer_load_dwordx4 v[28:31], v13, s[20:23], s90 offen
    buffer_load_dwordx4 v[32:35], v18, s[44:47], s91 offen
    buffer_load_dwordx4 v[36:39], v19, s[44:47], s91 offen
    buffer_load_dwordx4 v[40:43], v20, s[44:47], s91 offen
    buffer_load_dwordx4 v[44:47], v21, s[44:47], s91 offen
    ds_read_b128 v[48:51], v7 offset:0
    ds_read_b64_tr_b16 v[56:57], v9 offset:0
    ds_read_b64_tr_b16 v[58:59], v9 offset:1280
    ds_read_b64_tr_b16 v[60:61], v9 offset:64
    ds_read_b64_tr_b16 v[62:63], v9 offset:1344
    ds_read_b128 v[52:55], v7 offset:32
    ds_read_b64_tr_b16 v[64:65], v9 offset:5120
    ds_read_b64_tr_b16 v[66:67], v9 offset:6400
    ds_read_b64_tr_b16 v[68:69], v9 offset:5184
    ds_read_b64_tr_b16 v[70:71], v9 offset:6464
    s_waitcnt lgkmcnt(5)
    v_mfma_f32_32x32x16_bf16 v[104:119], v[56:59], v[48:51], v[104:119]
    v_mfma_f32_32x32x16_bf16 v[120:135], v[60:63], v[48:51], v[120:135]
    ds_read_b128 v[48:51], v7 offset:64
    ds_read_b64_tr_b16 v[56:57], v9 offset:10240
    ds_read_b64_tr_b16 v[58:59], v9 offset:11520
    ds_read_b64_tr_b16 v[60:61], v9 offset:10304
    ds_read_b64_tr_b16 v[62:63], v9 offset:11584
    s_waitcnt lgkmcnt(5)
    v_mfma_f32_32x32x16_bf16 v[104:119], v[64:67], v[52:55], v[104:119]
    v_mfma_f32_32x32x16_bf16 v[120:135], v[68:71], v[52:55], v[120:135]
    ds_read_b128 v[52:55], v7 offset:96
    ds_read_b64_tr_b16 v[64:65], v9 offset:15360
    ds_read_b64_tr_b16 v[66:67], v9 offset:16640
    ds_read_b64_tr_b16 v[68:69], v9 offset:15424
    ds_read_b64_tr_b16 v[70:71], v9 offset:16704
    s_waitcnt lgkmcnt(5)
    v_mfma_f32_32x32x16_bf16 v[104:119], v[56:59], v[48:51], v[104:119]
    v_mfma_f32_32x32x16_bf16 v[120:135], v[60:63], v[48:51], v[120:135]
    s_waitcnt lgkmcnt(0)
    v_mfma_f32_32x32x16_bf16 v[104:119], v[64:67], v[52:55], v[104:119]
    v_mfma_f32_32x32x16_bf16 v[120:135], v[68:71], v[52:55], v[120:135]
    s_waitcnt vmcnt(6)
    ds_write_b128 v4, v[136:139] offset:38912
    ds_write_b128 v4, v[140:143] offset:43520
    ds_write_b128 v6, v[144:147] offset:38912
    ds_write_b128 v6, v[148:151] offset:44032
    ds_write_b128 v6, v[152:155] offset:49152
    ds_write_b128 v6, v[156:159] offset:54272
    s_waitcnt lgkmcnt(0)
    s_barrier
    s_mov_b32 s90, 3200
    s_mov_b32 s91, 2048000
    buffer_load_dwordx4 v[136:139], v12, s[20:23], s90 offen
    buffer_load_dwordx4 v[140:143], v13, s[20:23], s90 offen
    buffer_load_dwordx4 v[144:147], v18, s[44:47], s91 offen
    buffer_load_dwordx4 v[148:151], v19, s[44:47], s91 offen
    buffer_load_dwordx4 v[152:155], v20, s[44:47], s91 offen
    buffer_load_dwordx4 v[156:159], v21, s[44:47], s91 offen
    ds_read_b128 v[48:51], v7 offset:38912
    ds_read_b64_tr_b16 v[56:57], v9 offset:38912
    ds_read_b64_tr_b16 v[58:59], v9 offset:40192
    ds_read_b64_tr_b16 v[60:61], v9 offset:38976
    ds_read_b64_tr_b16 v[62:63], v9 offset:40256
    ds_read_b128 v[52:55], v7 offset:38944
    ds_read_b64_tr_b16 v[64:65], v9 offset:44032
    ds_read_b64_tr_b16 v[66:67], v9 offset:45312
    ds_read_b64_tr_b16 v[68:69], v9 offset:44096
    ds_read_b64_tr_b16 v[70:71], v9 offset:45376
    s_waitcnt lgkmcnt(5)
    v_mfma_f32_32x32x16_bf16 v[104:119], v[56:59], v[48:51], v[104:119]
    v_mfma_f32_32x32x16_bf16 v[120:135], v[60:63], v[48:51], v[120:135]
    ds_read_b128 v[48:51], v7 offset:38976
    ds_read_b64_tr_b16 v[56:57], v9 offset:49152
    ds_read_b64_tr_b16 v[58:59], v9 offset:50432
    ds_read_b64_tr_b16 v[60:61], v9 offset:49216
    ds_read_b64_tr_b16 v[62:63], v9 offset:50496
    s_waitcnt lgkmcnt(5)
    v_mfma_f32_32x32x16_bf16 v[104:119], v[64:67], v[52:55], v[104:119]
    v_mfma_f32_32x32x16_bf16 v[120:135], v[68:71], v[52:55], v[120:135]
    ds_read_b128 v[52:55], v7 offset:39008
    ds_read_b64_tr_b16 v[64:65], v9 offset:54272
    ds_read_b64_tr_b16 v[66:67], v9 offset:55552
    ds_read_b64_tr_b16 v[68:69], v9 offset:54336
    ds_read_b64_tr_b16 v[70:71], v9 offset:55616
    s_waitcnt lgkmcnt(5)
    v_mfma_f32_32x32x16_bf16 v[104:119], v[56:59], v[48:51], v[104:119]
    v_mfma_f32_32x32x16_bf16 v[120:135], v[60:63], v[48:51], v[120:135]
    s_waitcnt lgkmcnt(0)
    v_mfma_f32_32x32x16_bf16 v[104:119], v[64:67], v[52:55], v[104:119]
    v_mfma_f32_32x32x16_bf16 v[120:135], v[68:71], v[52:55], v[120:135]
    s_waitcnt vmcnt(6)
    ds_write_b128 v4, v[24:27] offset:0
    ds_write_b128 v4, v[28:31] offset:4608
    ds_write_b128 v6, v[32:35] offset:0
    ds_write_b128 v6, v[36:39] offset:5120
    ds_write_b128 v6, v[40:43] offset:10240
    ds_write_b128 v6, v[44:47] offset:15360
    s_waitcnt lgkmcnt(0)
    s_barrier
    s_mov_b32 s90, 3328
    s_mov_b32 s91, 2129920
    buffer_load_dwordx4 v[24:27], v12, s[20:23], s90 offen
    buffer_load_dwordx4 v[28:31], v13, s[20:23], s90 offen
    buffer_load_dwordx4 v[32:35], v18, s[44:47], s91 offen
    buffer_load_dwordx4 v[36:39], v19, s[44:47], s91 offen
    buffer_load_dwordx4 v[40:43], v20, s[44:47], s91 offen
    buffer_load_dwordx4 v[44:47], v21, s[44:47], s91 offen
    ds_read_b128 v[48:51], v7 offset:0
    ds_read_b64_tr_b16 v[56:57], v9 offset:0
    ds_read_b64_tr_b16 v[58:59], v9 offset:1280
    ds_read_b64_tr_b16 v[60:61], v9 offset:64
    ds_read_b64_tr_b16 v[62:63], v9 offset:1344
    ds_read_b128 v[52:55], v7 offset:32
    ds_read_b64_tr_b16 v[64:65], v9 offset:5120
    ds_read_b64_tr_b16 v[66:67], v9 offset:6400
    ds_read_b64_tr_b16 v[68:69], v9 offset:5184
    ds_read_b64_tr_b16 v[70:71], v9 offset:6464
    s_waitcnt lgkmcnt(5)
    v_mfma_f32_32x32x16_bf16 v[104:119], v[56:59], v[48:51], v[104:119]
    v_mfma_f32_32x32x16_bf16 v[120:135], v[60:63], v[48:51], v[120:135]
    ds_read_b128 v[48:51], v7 offset:64
    ds_read_b64_tr_b16 v[56:57], v9 offset:10240
    ds_read_b64_tr_b16 v[58:59], v9 offset:11520
    ds_read_b64_tr_b16 v[60:61], v9 offset:10304
    ds_read_b64_tr_b16 v[62:63], v9 offset:11584
    s_waitcnt lgkmcnt(5)
    v_mfma_f32_32x32x16_bf16 v[104:119], v[64:67], v[52:55], v[104:119]
    v_mfma_f32_32x32x16_bf16 v[120:135], v[68:71], v[52:55], v[120:135]
    ds_read_b128 v[52:55], v7 offset:96
    ds_read_b64_tr_b16 v[64:65], v9 offset:15360
    ds_read_b64_tr_b16 v[66:67], v9 offset:16640
    ds_read_b64_tr_b16 v[68:69], v9 offset:15424
    ds_read_b64_tr_b16 v[70:71], v9 offset:16704
    s_waitcnt lgkmcnt(5)
    v_mfma_f32_32x32x16_bf16 v[104:119], v[56:59], v[48:51], v[104:119]
    v_mfma_f32_32x32x16_bf16 v[120:135], v[60:63], v[48:51], v[120:135]
    s_waitcnt lgkmcnt(0)
    v_mfma_f32_32x32x16_bf16 v[104:119], v[64:67], v[52:55], v[104:119]
    v_mfma_f32_32x32x16_bf16 v[120:135], v[68:71], v[52:55], v[120:135]
    s_waitcnt vmcnt(6)
    ds_write_b128 v4, v[136:139] offset:38912
    ds_write_b128 v4, v[140:143] offset:43520
    ds_write_b128 v6, v[144:147] offset:38912
    ds_write_b128 v6, v[148:151] offset:44032
    ds_write_b128 v6, v[152:155] offset:49152
    ds_write_b128 v6, v[156:159] offset:54272
    s_waitcnt lgkmcnt(0)
    s_barrier
    ds_read_b128 v[48:51], v7 offset:38912
    ds_read_b64_tr_b16 v[56:57], v9 offset:38912
    ds_read_b64_tr_b16 v[58:59], v9 offset:40192
    ds_read_b64_tr_b16 v[60:61], v9 offset:38976
    ds_read_b64_tr_b16 v[62:63], v9 offset:40256
    ds_read_b128 v[52:55], v7 offset:38944
    ds_read_b64_tr_b16 v[64:65], v9 offset:44032
    ds_read_b64_tr_b16 v[66:67], v9 offset:45312
    ds_read_b64_tr_b16 v[68:69], v9 offset:44096
    ds_read_b64_tr_b16 v[70:71], v9 offset:45376
    s_waitcnt lgkmcnt(5)
    v_mfma_f32_32x32x16_bf16 v[104:119], v[56:59], v[48:51], v[104:119]
    v_mfma_f32_32x32x16_bf16 v[120:135], v[60:63], v[48:51], v[120:135]
    ds_read_b128 v[48:51], v7 offset:38976
    ds_read_b64_tr_b16 v[56:57], v9 offset:49152
    ds_read_b64_tr_b16 v[58:59], v9 offset:50432
    ds_read_b64_tr_b16 v[60:61], v9 offset:49216
    ds_read_b64_tr_b16 v[62:63], v9 offset:50496
    s_waitcnt lgkmcnt(5)
    v_mfma_f32_32x32x16_bf16 v[104:119], v[64:67], v[52:55], v[104:119]
    v_mfma_f32_32x32x16_bf16 v[120:135], v[68:71], v[52:55], v[120:135]
    ds_read_b128 v[52:55], v7 offset:39008
    ds_read_b64_tr_b16 v[64:65], v9 offset:54272
    ds_read_b64_tr_b16 v[66:67], v9 offset:55552
    ds_read_b64_tr_b16 v[68:69], v9 offset:54336
    ds_read_b64_tr_b16 v[70:71], v9 offset:55616
    s_waitcnt lgkmcnt(5)
    v_mfma_f32_32x32x16_bf16 v[104:119], v[56:59], v[48:51], v[104:119]
    v_mfma_f32_32x32x16_bf16 v[120:135], v[60:63], v[48:51], v[120:135]
    s_waitcnt lgkmcnt(0)
    v_mfma_f32_32x32x16_bf16 v[104:119], v[64:67], v[52:55], v[104:119]
    v_mfma_f32_32x32x16_bf16 v[120:135], v[68:71], v[52:55], v[120:135]
    s_waitcnt vmcnt(0)
    ds_write_b128 v4, v[24:27] offset:0
    ds_write_b128 v4, v[28:31] offset:4608
    ds_write_b128 v6, v[32:35] offset:0
    ds_write_b128 v6, v[36:39] offset:5120
    ds_write_b128 v6, v[40:43] offset:10240
    ds_write_b128 v6, v[44:47] offset:15360
    s_waitcnt lgkmcnt(0)
    s_barrier
    ds_read_b128 v[48:51], v7 offset:0
    ds_read_b64_tr_b16 v[56:57], v9 offset:0
    ds_read_b64_tr_b16 v[58:59], v9 offset:1280
    ds_read_b64_tr_b16 v[60:61], v9 offset:64
    ds_read_b64_tr_b16 v[62:63], v9 offset:1344
    ds_read_b128 v[52:55], v7 offset:32
    ds_read_b64_tr_b16 v[64:65], v9 offset:5120
    ds_read_b64_tr_b16 v[66:67], v9 offset:6400
    ds_read_b64_tr_b16 v[68:69], v9 offset:5184
    ds_read_b64_tr_b16 v[70:71], v9 offset:6464
    s_waitcnt lgkmcnt(5)
    v_mfma_f32_32x32x16_bf16 v[104:119], v[56:59], v[48:51], v[104:119]
    v_mfma_f32_32x32x16_bf16 v[120:135], v[60:63], v[48:51], v[120:135]
    ds_read_b128 v[48:51], v7 offset:64
    ds_read_b64_tr_b16 v[56:57], v9 offset:10240
    ds_read_b64_tr_b16 v[58:59], v9 offset:11520
    ds_read_b64_tr_b16 v[60:61], v9 offset:10304
    ds_read_b64_tr_b16 v[62:63], v9 offset:11584
    s_waitcnt lgkmcnt(5)
    v_mfma_f32_32x32x16_bf16 v[104:119], v[64:67], v[52:55], v[104:119]
    v_mfma_f32_32x32x16_bf16 v[120:135], v[68:71], v[52:55], v[120:135]
    ds_read_b128 v[52:55], v7 offset:96
    ds_read_b64_tr_b16 v[64:65], v9 offset:15360
    ds_read_b64_tr_b16 v[66:67], v9 offset:16640
    ds_read_b64_tr_b16 v[68:69], v9 offset:15424
    ds_read_b64_tr_b16 v[70:71], v9 offset:16704
    s_waitcnt lgkmcnt(5)
    v_mfma_f32_32x32x16_bf16 v[104:119], v[56:59], v[48:51], v[104:119]
    v_mfma_f32_32x32x16_bf16 v[120:135], v[60:63], v[48:51], v[120:135]
    s_waitcnt lgkmcnt(0)
    v_mfma_f32_32x32x16_bf16 v[104:119], v[64:67], v[52:55], v[104:119]
    v_mfma_f32_32x32x16_bf16 v[120:135], v[68:71], v[52:55], v[120:135]
    s_barrier
    s_mov_b32 s8, s4
    s_mov_b32 s9, s5
    s_mov_b32 s10, 2621440
    s_mov_b32 s11, 0x00020000
    s_mov_b32 s12, s28
    s_mov_b32 s13, s29
    s_mov_b32 s14, 1280
    s_mov_b32 s15, 0x00020000
    s_add_u32 s16, s36, 27262976
    s_addc_u32 s17, s37, 0
    s_mov_b32 s18, 8192
    s_mov_b32 s19, 0x00020000
    s_mov_b32 s20, s32
    s_mov_b32 s21, s33
    s_mov_b32 s22, 5242880
    s_mov_b32 s23, 0x00020000
    v_and_b32 v1, 31, v0
    v_lshrrev_b32 v2, 7, v0
    v_lshl_add_u32 v1, v2, 5, v1
    v_add_u32 v1, s41, v1
    v_lshlrev_b32 v2, 2, v1
    buffer_load_dword v10, v2, s[16:19], 0 offen
    v_bfe_u32 v2, v0, 6, 1
    v_lshlrev_b32 v2, 6, v2
    v_bfe_u32 v3, v0, 5, 1
    v_lshl_add_u32 v2, v3, 2, v2
    v_add_u32 v2, s43, v2
    v_mul_u32_u24 v3, 640, v1
    v_add_u32 v3, v3, v2
    v_lshlrev_b32 v4, 1, v3
    v_lshlrev_b32 v5, 2, v3
    v_lshlrev_b32 v6, 1, v2
    buffer_load_dwordx2 v[12:13], v4, s[8:11], 0 offen offset:0
    buffer_load_dwordx2 v[28:29], v6, s[12:15], 0 offen offset:0
    buffer_load_dwordx2 v[14:15], v4, s[8:11], 0 offen offset:16
    buffer_load_dwordx2 v[30:31], v6, s[12:15], 0 offen offset:16
    buffer_load_dwordx2 v[16:17], v4, s[8:11], 0 offen offset:32
    buffer_load_dwordx2 v[32:33], v6, s[12:15], 0 offen offset:32
    buffer_load_dwordx2 v[18:19], v4, s[8:11], 0 offen offset:48
    buffer_load_dwordx2 v[34:35], v6, s[12:15], 0 offen offset:48
    buffer_load_dwordx2 v[20:21], v4, s[8:11], 0 offen offset:64
    buffer_load_dwordx2 v[36:37], v6, s[12:15], 0 offen offset:64
    buffer_load_dwordx2 v[22:23], v4, s[8:11], 0 offen offset:80
    buffer_load_dwordx2 v[38:39], v6, s[12:15], 0 offen offset:80
    buffer_load_dwordx2 v[24:25], v4, s[8:11], 0 offen offset:96
    buffer_load_dwordx2 v[40:41], v6, s[12:15], 0 offen offset:96
    buffer_load_dwordx2 v[26:27], v4, s[8:11], 0 offen offset:112
    buffer_load_dwordx2 v[42:43], v6, s[12:15], 0 offen offset:112
    s_waitcnt vmcnt(0)
    v_sub_f32 v11, 1.0, v10
    v_cvt_pk_bf16_f32 v11, v11, v11
    v_lshlrev_b32 v11, 16, v11
    v_lshlrev_b32 v44, 16, v12
    v_lshlrev_b32 v45, 16, v28
    v_mul_f32 v44, v44, v45
    v_cvt_pk_bf16_f32 v44, v44, v104
    v_lshlrev_b32 v45, 16, v44
    v_and_b32 v44, 0xffff0000, v44
    v_fma_f32 v45, 2.0, v72, v45
    v_mul_f32 v44, v11, v44
    v_cvt_pk_bf16_f32 v44, v44, v44
    v_lshlrev_b32 v44, 16, v44
    v_mul_f32 v45, v10, v45
    v_add_f32 v72, v45, v44
    v_and_b32 v44, 0xffff0000, v12
    v_and_b32 v45, 0xffff0000, v28
    v_mul_f32 v44, v44, v45
    v_cvt_pk_bf16_f32 v44, v44, v105
    v_lshlrev_b32 v45, 16, v44
    v_and_b32 v44, 0xffff0000, v44
    v_fma_f32 v45, 2.0, v73, v45
    v_mul_f32 v44, v11, v44
    v_cvt_pk_bf16_f32 v44, v44, v44
    v_lshlrev_b32 v44, 16, v44
    v_mul_f32 v45, v10, v45
    v_add_f32 v73, v45, v44
    v_lshlrev_b32 v44, 16, v13
    v_lshlrev_b32 v45, 16, v29
    v_mul_f32 v44, v44, v45
    v_cvt_pk_bf16_f32 v44, v44, v106
    v_lshlrev_b32 v45, 16, v44
    v_and_b32 v44, 0xffff0000, v44
    v_fma_f32 v45, 2.0, v74, v45
    v_mul_f32 v44, v11, v44
    v_cvt_pk_bf16_f32 v44, v44, v44
    v_lshlrev_b32 v44, 16, v44
    v_mul_f32 v45, v10, v45
    v_add_f32 v74, v45, v44
    v_and_b32 v44, 0xffff0000, v13
    v_and_b32 v45, 0xffff0000, v29
    v_mul_f32 v44, v44, v45
    v_cvt_pk_bf16_f32 v44, v44, v107
    v_lshlrev_b32 v45, 16, v44
    v_and_b32 v44, 0xffff0000, v44
    v_fma_f32 v45, 2.0, v75, v45
    v_mul_f32 v44, v11, v44
    v_cvt_pk_bf16_f32 v44, v44, v44
    v_lshlrev_b32 v44, 16, v44
    v_mul_f32 v45, v10, v45
    v_add_f32 v75, v45, v44
    buffer_store_dwordx4 v[72:75], v5, s[20:23], 0 offen offset:0
    v_lshlrev_b32 v44, 16, v14
    v_lshlrev_b32 v45, 16, v30
    v_mul_f32 v44, v44, v45
    v_cvt_pk_bf16_f32 v44, v44, v108
    v_lshlrev_b32 v45, 16, v44
    v_and_b32 v44, 0xffff0000, v44
    v_fma_f32 v45, 2.0, v76, v45
    v_mul_f32 v44, v11, v44
    v_cvt_pk_bf16_f32 v44, v44, v44
    v_lshlrev_b32 v44, 16, v44
    v_mul_f32 v45, v10, v45
    v_add_f32 v76, v45, v44
    v_and_b32 v44, 0xffff0000, v14
    v_and_b32 v45, 0xffff0000, v30
    v_mul_f32 v44, v44, v45
    v_cvt_pk_bf16_f32 v44, v44, v109
    v_lshlrev_b32 v45, 16, v44
    v_and_b32 v44, 0xffff0000, v44
    v_fma_f32 v45, 2.0, v77, v45
    v_mul_f32 v44, v11, v44
    v_cvt_pk_bf16_f32 v44, v44, v44
    v_lshlrev_b32 v44, 16, v44
    v_mul_f32 v45, v10, v45
    v_add_f32 v77, v45, v44
    v_lshlrev_b32 v44, 16, v15
    v_lshlrev_b32 v45, 16, v31
    v_mul_f32 v44, v44, v45
    v_cvt_pk_bf16_f32 v44, v44, v110
    v_lshlrev_b32 v45, 16, v44
    v_and_b32 v44, 0xffff0000, v44
    v_fma_f32 v45, 2.0, v78, v45
    v_mul_f32 v44, v11, v44
    v_cvt_pk_bf16_f32 v44, v44, v44
    v_lshlrev_b32 v44, 16, v44
    v_mul_f32 v45, v10, v45
    v_add_f32 v78, v45, v44
    v_and_b32 v44, 0xffff0000, v15
    v_and_b32 v45, 0xffff0000, v31
    v_mul_f32 v44, v44, v45
    v_cvt_pk_bf16_f32 v44, v44, v111
    v_lshlrev_b32 v45, 16, v44
    v_and_b32 v44, 0xffff0000, v44
    v_fma_f32 v45, 2.0, v79, v45
    v_mul_f32 v44, v11, v44
    v_cvt_pk_bf16_f32 v44, v44, v44
    v_lshlrev_b32 v44, 16, v44
    v_mul_f32 v45, v10, v45
    v_add_f32 v79, v45, v44
    buffer_store_dwordx4 v[76:79], v5, s[20:23], 0 offen offset:32
    v_lshlrev_b32 v44, 16, v16
    v_lshlrev_b32 v45, 16, v32
    v_mul_f32 v44, v44, v45
    v_cvt_pk_bf16_f32 v44, v44, v112
    v_lshlrev_b32 v45, 16, v44
    v_and_b32 v44, 0xffff0000, v44
    v_fma_f32 v45, 2.0, v80, v45
    v_mul_f32 v44, v11, v44
    v_cvt_pk_bf16_f32 v44, v44, v44
    v_lshlrev_b32 v44, 16, v44
    v_mul_f32 v45, v10, v45
    v_add_f32 v80, v45, v44
    v_and_b32 v44, 0xffff0000, v16
    v_and_b32 v45, 0xffff0000, v32
    v_mul_f32 v44, v44, v45
    v_cvt_pk_bf16_f32 v44, v44, v113
    v_lshlrev_b32 v45, 16, v44
    v_and_b32 v44, 0xffff0000, v44
    v_fma_f32 v45, 2.0, v81, v45
    v_mul_f32 v44, v11, v44
    v_cvt_pk_bf16_f32 v44, v44, v44
    v_lshlrev_b32 v44, 16, v44
    v_mul_f32 v45, v10, v45
    v_add_f32 v81, v45, v44
    v_lshlrev_b32 v44, 16, v17
    v_lshlrev_b32 v45, 16, v33
    v_mul_f32 v44, v44, v45
    v_cvt_pk_bf16_f32 v44, v44, v114
    v_lshlrev_b32 v45, 16, v44
    v_and_b32 v44, 0xffff0000, v44
    v_fma_f32 v45, 2.0, v82, v45
    v_mul_f32 v44, v11, v44
    v_cvt_pk_bf16_f32 v44, v44, v44
    v_lshlrev_b32 v44, 16, v44
    v_mul_f32 v45, v10, v45
    v_add_f32 v82, v45, v44
    v_and_b32 v44, 0xffff0000, v17
    v_and_b32 v45, 0xffff0000, v33
    v_mul_f32 v44, v44, v45
    v_cvt_pk_bf16_f32 v44, v44, v115
    v_lshlrev_b32 v45, 16, v44
    v_and_b32 v44, 0xffff0000, v44
    v_fma_f32 v45, 2.0, v83, v45
    v_mul_f32 v44, v11, v44
    v_cvt_pk_bf16_f32 v44, v44, v44
    v_lshlrev_b32 v44, 16, v44
    v_mul_f32 v45, v10, v45
    v_add_f32 v83, v45, v44
    buffer_store_dwordx4 v[80:83], v5, s[20:23], 0 offen offset:64
    v_lshlrev_b32 v44, 16, v18
    v_lshlrev_b32 v45, 16, v34
    v_mul_f32 v44, v44, v45
    v_cvt_pk_bf16_f32 v44, v44, v116
    v_lshlrev_b32 v45, 16, v44
    v_and_b32 v44, 0xffff0000, v44
    v_fma_f32 v45, 2.0, v84, v45
    v_mul_f32 v44, v11, v44
    v_cvt_pk_bf16_f32 v44, v44, v44
    v_lshlrev_b32 v44, 16, v44
    v_mul_f32 v45, v10, v45
    v_add_f32 v84, v45, v44
    v_and_b32 v44, 0xffff0000, v18
    v_and_b32 v45, 0xffff0000, v34
    v_mul_f32 v44, v44, v45
    v_cvt_pk_bf16_f32 v44, v44, v117
    v_lshlrev_b32 v45, 16, v44
    v_and_b32 v44, 0xffff0000, v44
    v_fma_f32 v45, 2.0, v85, v45
    v_mul_f32 v44, v11, v44
    v_cvt_pk_bf16_f32 v44, v44, v44
    v_lshlrev_b32 v44, 16, v44
    v_mul_f32 v45, v10, v45
    v_add_f32 v85, v45, v44
    v_lshlrev_b32 v44, 16, v19
    v_lshlrev_b32 v45, 16, v35
    v_mul_f32 v44, v44, v45
    v_cvt_pk_bf16_f32 v44, v44, v118
    v_lshlrev_b32 v45, 16, v44
    v_and_b32 v44, 0xffff0000, v44
    v_fma_f32 v45, 2.0, v86, v45
    v_mul_f32 v44, v11, v44
    v_cvt_pk_bf16_f32 v44, v44, v44
    v_lshlrev_b32 v44, 16, v44
    v_mul_f32 v45, v10, v45
    v_add_f32 v86, v45, v44
    v_and_b32 v44, 0xffff0000, v19
    v_and_b32 v45, 0xffff0000, v35
    v_mul_f32 v44, v44, v45
    v_cvt_pk_bf16_f32 v44, v44, v119
    v_lshlrev_b32 v45, 16, v44
    v_and_b32 v44, 0xffff0000, v44
    v_fma_f32 v45, 2.0, v87, v45
    v_mul_f32 v44, v11, v44
    v_cvt_pk_bf16_f32 v44, v44, v44
    v_lshlrev_b32 v44, 16, v44
    v_mul_f32 v45, v10, v45
    v_add_f32 v87, v45, v44
    buffer_store_dwordx4 v[84:87], v5, s[20:23], 0 offen offset:96
    v_lshlrev_b32 v44, 16, v20
    v_lshlrev_b32 v45, 16, v36
    v_mul_f32 v44, v44, v45
    v_cvt_pk_bf16_f32 v44, v44, v120
    v_lshlrev_b32 v45, 16, v44
    v_and_b32 v44, 0xffff0000, v44
    v_fma_f32 v45, 2.0, v88, v45
    v_mul_f32 v44, v11, v44
    v_cvt_pk_bf16_f32 v44, v44, v44
    v_lshlrev_b32 v44, 16, v44
    v_mul_f32 v45, v10, v45
    v_add_f32 v88, v45, v44
    v_and_b32 v44, 0xffff0000, v20
    v_and_b32 v45, 0xffff0000, v36
    v_mul_f32 v44, v44, v45
    v_cvt_pk_bf16_f32 v44, v44, v121
    v_lshlrev_b32 v45, 16, v44
    v_and_b32 v44, 0xffff0000, v44
    v_fma_f32 v45, 2.0, v89, v45
    v_mul_f32 v44, v11, v44
    v_cvt_pk_bf16_f32 v44, v44, v44
    v_lshlrev_b32 v44, 16, v44
    v_mul_f32 v45, v10, v45
    v_add_f32 v89, v45, v44
    v_lshlrev_b32 v44, 16, v21
    v_lshlrev_b32 v45, 16, v37
    v_mul_f32 v44, v44, v45
    v_cvt_pk_bf16_f32 v44, v44, v122
    v_lshlrev_b32 v45, 16, v44
    v_and_b32 v44, 0xffff0000, v44
    v_fma_f32 v45, 2.0, v90, v45
    v_mul_f32 v44, v11, v44
    v_cvt_pk_bf16_f32 v44, v44, v44
    v_lshlrev_b32 v44, 16, v44
    v_mul_f32 v45, v10, v45
    v_add_f32 v90, v45, v44
    v_and_b32 v44, 0xffff0000, v21
    v_and_b32 v45, 0xffff0000, v37
    v_mul_f32 v44, v44, v45
    v_cvt_pk_bf16_f32 v44, v44, v123
    v_lshlrev_b32 v45, 16, v44
    v_and_b32 v44, 0xffff0000, v44
    v_fma_f32 v45, 2.0, v91, v45
    v_mul_f32 v44, v11, v44
    v_cvt_pk_bf16_f32 v44, v44, v44
    v_lshlrev_b32 v44, 16, v44
    v_mul_f32 v45, v10, v45
    v_add_f32 v91, v45, v44
    buffer_store_dwordx4 v[88:91], v5, s[20:23], 0 offen offset:128
    v_lshlrev_b32 v44, 16, v22
    v_lshlrev_b32 v45, 16, v38
    v_mul_f32 v44, v44, v45
    v_cvt_pk_bf16_f32 v44, v44, v124
    v_lshlrev_b32 v45, 16, v44
    v_and_b32 v44, 0xffff0000, v44
    v_fma_f32 v45, 2.0, v92, v45
    v_mul_f32 v44, v11, v44
    v_cvt_pk_bf16_f32 v44, v44, v44
    v_lshlrev_b32 v44, 16, v44
    v_mul_f32 v45, v10, v45
    v_add_f32 v92, v45, v44
    v_and_b32 v44, 0xffff0000, v22
    v_and_b32 v45, 0xffff0000, v38
    v_mul_f32 v44, v44, v45
    v_cvt_pk_bf16_f32 v44, v44, v125
    v_lshlrev_b32 v45, 16, v44
    v_and_b32 v44, 0xffff0000, v44
    v_fma_f32 v45, 2.0, v93, v45
    v_mul_f32 v44, v11, v44
    v_cvt_pk_bf16_f32 v44, v44, v44
    v_lshlrev_b32 v44, 16, v44
    v_mul_f32 v45, v10, v45
    v_add_f32 v93, v45, v44
    v_lshlrev_b32 v44, 16, v23
    v_lshlrev_b32 v45, 16, v39
    v_mul_f32 v44, v44, v45
    v_cvt_pk_bf16_f32 v44, v44, v126
    v_lshlrev_b32 v45, 16, v44
    v_and_b32 v44, 0xffff0000, v44
    v_fma_f32 v45, 2.0, v94, v45
    v_mul_f32 v44, v11, v44
    v_cvt_pk_bf16_f32 v44, v44, v44
    v_lshlrev_b32 v44, 16, v44
    v_mul_f32 v45, v10, v45
    v_add_f32 v94, v45, v44
    v_and_b32 v44, 0xffff0000, v23
    v_and_b32 v45, 0xffff0000, v39
    v_mul_f32 v44, v44, v45
    v_cvt_pk_bf16_f32 v44, v44, v127
    v_lshlrev_b32 v45, 16, v44
    v_and_b32 v44, 0xffff0000, v44
    v_fma_f32 v45, 2.0, v95, v45
    v_mul_f32 v44, v11, v44
    v_cvt_pk_bf16_f32 v44, v44, v44
    v_lshlrev_b32 v44, 16, v44
    v_mul_f32 v45, v10, v45
    v_add_f32 v95, v45, v44
    buffer_store_dwordx4 v[92:95], v5, s[20:23], 0 offen offset:160
    v_lshlrev_b32 v44, 16, v24
    v_lshlrev_b32 v45, 16, v40
    v_mul_f32 v44, v44, v45
    v_cvt_pk_bf16_f32 v44, v44, v128
    v_lshlrev_b32 v45, 16, v44
    v_and_b32 v44, 0xffff0000, v44
    v_fma_f32 v45, 2.0, v96, v45
    v_mul_f32 v44, v11, v44
    v_cvt_pk_bf16_f32 v44, v44, v44
    v_lshlrev_b32 v44, 16, v44
    v_mul_f32 v45, v10, v45
    v_add_f32 v96, v45, v44
    v_and_b32 v44, 0xffff0000, v24
    v_and_b32 v45, 0xffff0000, v40
    v_mul_f32 v44, v44, v45
    v_cvt_pk_bf16_f32 v44, v44, v129
    v_lshlrev_b32 v45, 16, v44
    v_and_b32 v44, 0xffff0000, v44
    v_fma_f32 v45, 2.0, v97, v45
    v_mul_f32 v44, v11, v44
    v_cvt_pk_bf16_f32 v44, v44, v44
    v_lshlrev_b32 v44, 16, v44
    v_mul_f32 v45, v10, v45
    v_add_f32 v97, v45, v44
    v_lshlrev_b32 v44, 16, v25
    v_lshlrev_b32 v45, 16, v41
    v_mul_f32 v44, v44, v45
    v_cvt_pk_bf16_f32 v44, v44, v130
    v_lshlrev_b32 v45, 16, v44
    v_and_b32 v44, 0xffff0000, v44
    v_fma_f32 v45, 2.0, v98, v45
    v_mul_f32 v44, v11, v44
    v_cvt_pk_bf16_f32 v44, v44, v44
    v_lshlrev_b32 v44, 16, v44
    v_mul_f32 v45, v10, v45
    v_add_f32 v98, v45, v44
    v_and_b32 v44, 0xffff0000, v25
    v_and_b32 v45, 0xffff0000, v41
    v_mul_f32 v44, v44, v45
    v_cvt_pk_bf16_f32 v44, v44, v131
    v_lshlrev_b32 v45, 16, v44
    v_and_b32 v44, 0xffff0000, v44
    v_fma_f32 v45, 2.0, v99, v45
    v_mul_f32 v44, v11, v44
    v_cvt_pk_bf16_f32 v44, v44, v44
    v_lshlrev_b32 v44, 16, v44
    v_mul_f32 v45, v10, v45
    v_add_f32 v99, v45, v44
    buffer_store_dwordx4 v[96:99], v5, s[20:23], 0 offen offset:192
    v_lshlrev_b32 v44, 16, v26
    v_lshlrev_b32 v45, 16, v42
    v_mul_f32 v44, v44, v45
    v_cvt_pk_bf16_f32 v44, v44, v132
    v_lshlrev_b32 v45, 16, v44
    v_and_b32 v44, 0xffff0000, v44
    v_fma_f32 v45, 2.0, v100, v45
    v_mul_f32 v44, v11, v44
    v_cvt_pk_bf16_f32 v44, v44, v44
    v_lshlrev_b32 v44, 16, v44
    v_mul_f32 v45, v10, v45
    v_add_f32 v100, v45, v44
    v_and_b32 v44, 0xffff0000, v26
    v_and_b32 v45, 0xffff0000, v42
    v_mul_f32 v44, v44, v45
    v_cvt_pk_bf16_f32 v44, v44, v133
    v_lshlrev_b32 v45, 16, v44
    v_and_b32 v44, 0xffff0000, v44
    v_fma_f32 v45, 2.0, v101, v45
    v_mul_f32 v44, v11, v44
    v_cvt_pk_bf16_f32 v44, v44, v44
    v_lshlrev_b32 v44, 16, v44
    v_mul_f32 v45, v10, v45
    v_add_f32 v101, v45, v44
    v_lshlrev_b32 v44, 16, v27
    v_lshlrev_b32 v45, 16, v43
    v_mul_f32 v44, v44, v45
    v_cvt_pk_bf16_f32 v44, v44, v134
    v_lshlrev_b32 v45, 16, v44
    v_and_b32 v44, 0xffff0000, v44
    v_fma_f32 v45, 2.0, v102, v45
    v_mul_f32 v44, v11, v44
    v_cvt_pk_bf16_f32 v44, v44, v44
    v_lshlrev_b32 v44, 16, v44
    v_mul_f32 v45, v10, v45
    v_add_f32 v102, v45, v44
    v_and_b32 v44, 0xffff0000, v27
    v_and_b32 v45, 0xffff0000, v43
    v_mul_f32 v44, v44, v45
    v_cvt_pk_bf16_f32 v44, v44, v135
    v_lshlrev_b32 v45, 16, v44
    v_and_b32 v44, 0xffff0000, v44
    v_fma_f32 v45, 2.0, v103, v45
    v_mul_f32 v44, v11, v44
    v_cvt_pk_bf16_f32 v44, v44, v44
    v_lshlrev_b32 v44, 16, v44
    v_mul_f32 v45, v10, v45
    v_add_f32 v103, v45, v44
    buffer_store_dwordx4 v[100:103], v5, s[20:23], 0 offen offset:224
K3_END:
    s_endpgm
.section .rodata,"a"
.p2align 6
.amdhsa_kernel k1_kernel
  .amdhsa_next_free_vgpr 160
  .amdhsa_next_free_sgpr 100
  .amdhsa_accum_offset 160
  .amdhsa_group_segment_fixed_size 0
  .amdhsa_kernarg_size 128
  .amdhsa_user_sgpr_count 2
  .amdhsa_user_sgpr_kernarg_segment_ptr 1
  .amdhsa_system_sgpr_workgroup_id_x 1
.end_amdhsa_kernel
.p2align 6
.amdhsa_kernel k2_kernel
  .amdhsa_next_free_vgpr 104
  .amdhsa_next_free_sgpr 100
  .amdhsa_accum_offset 104
  .amdhsa_group_segment_fixed_size 0
  .amdhsa_kernarg_size 128
  .amdhsa_user_sgpr_count 2
  .amdhsa_user_sgpr_kernarg_segment_ptr 1
  .amdhsa_system_sgpr_workgroup_id_x 1
.end_amdhsa_kernel
.p2align 6
.amdhsa_kernel k3_kernel
  .amdhsa_next_free_vgpr 160
  .amdhsa_next_free_sgpr 100
  .amdhsa_accum_offset 160
  .amdhsa_group_segment_fixed_size 0
  .amdhsa_kernarg_size 128
  .amdhsa_user_sgpr_count 2
  .amdhsa_user_sgpr_kernarg_segment_ptr 1
  .amdhsa_system_sgpr_workgroup_id_x 1
.end_amdhsa_kernel
```
